```python
import torch

def _softmax(x, axis=-1):
    return torch.softmax(x, dim=axis)
def _gelu(x):
    return torch.nn.functional.gelu(x, approximate="tanh")
def _silu(x):
    return torch.nn.functional.silu(x)
def _sigmoid(x):
    return torch.sigmoid(x)
def _layernorm(x, axis=-1, eps=1e-5):
    m = x.mean(dim=axis, keepdim=True)
    v = x.var(dim=axis, keepdim=True, unbiased=False)
    return (x - m) / torch.sqrt(v + eps)
def _scatter_add(tgt, idx, src, axis=0):
    return tgt.clone().index_add_(axis, idx, src)
def _segment_sum(src, seg, n):
    out = torch.zeros((n,) + src.shape[1:], dtype=src.dtype)
    return out.index_add_(0, seg, src)
def _pad(x, pw):
    flat = tuple(v for pair in reversed(pw) for v in pair)
    return torch.nn.functional.pad(x, flat)

kernel_name = 'recurrent_scan__compressed_kv_cla__dense_activation_gelu__decode'

def setup_inputs():

    _w = (lambda a: (lambda t: t.to(torch.bfloat16) if t.is_floating_point() else t)(torch.as_tensor(a)))
    def _A_setup():
        B, H, Sq, Sk, D, M = 1, 32, 1, 8192, 192, 640
        Dc = 4 * D
        return {
            "x": _w((lambda *s: torch.randn(*s, dtype=torch.bfloat16) * 0.1)(B, Sq, M)),
            "c_kv": _w((lambda *s: torch.randn(*s, dtype=torch.bfloat16) * 3.2)(B, Sk, Dc)),
            "w_q": _w((lambda *s: torch.randn(*s, dtype=torch.bfloat16) * 0.8)(M, H, D) * (M ** -0.5)),
            "w_uk": _w((lambda *s: torch.randn(*s, dtype=torch.bfloat16) * 0.8)(Dc, H, D) * (Dc ** -0.5)),
            "w_uv": _w((lambda *s: torch.randn(*s, dtype=torch.bfloat16) * 3.2)(Dc, H, D) * (Dc ** -0.5)),
            "w_o": _w((lambda *s: torch.randn(*s, dtype=torch.bfloat16) * 3.2)(H, D, M) * ((H * D) ** -0.5)),
        }
    _A_in = _A_setup()

    def _B_setup():
        B, S, D, F = 1, 1, 640, 1536
        return {
            "x": _w((lambda *s: torch.randn(*s, dtype=torch.bfloat16) * 0.1)(B, S, D)),
            "w1": _w((lambda *s: torch.randn(*s, dtype=torch.bfloat16) * 3.2)(D, F) * (D ** -0.5)),
            "b1": _w((lambda *s: torch.randn(*s, dtype=torch.bfloat16) * 3.2)(F) * 0.01),
            "w2": _w((lambda *s: torch.randn(*s, dtype=torch.bfloat16) * 3.2)(F, D) * (F ** -0.5)),
            "b2": _w((lambda *s: torch.randn(*s, dtype=torch.bfloat16) * 3.2)(D) * 0.01),
        }
    _B_in = _B_setup()

    return {
        "A_x": _A_in["x"],
        "A_c_kv": _A_in["c_kv"],
        "A_w_q": _A_in["w_q"],
        "A_w_uk": _A_in["w_uk"],
        "A_w_uv": _A_in["w_uv"],
        "A_w_o": _A_in["w_o"],
        "B_x": _B_in["x"],
        "B_w1": _B_in["w1"],
        "B_b1": _B_in["b1"],
        "B_w2": _B_in["w2"],
        "B_b2": _B_in["b2"],
    }

def reference(A_x, A_c_kv, A_w_q, A_w_uk, A_w_uv, A_w_o, B_x, B_w1, B_b1, B_w2, B_b2):
    def _A_ref(x, c_kv, w_q, w_uk, w_uv, w_o):
        B, Sq, M = x.shape[0], x.shape[1], x.shape[2]
        Sk = c_kv.shape[1]
        H, D = w_q.shape[1], w_q.shape[2]
        q = torch.einsum("bqm,mhd->bhqd", x, w_q)
        k = torch.einsum("bkc,chd->bhkd", c_kv, w_uk)
        v = torch.einsum("bkc,chd->bhkd", c_kv, w_uv)
        scores = torch.einsum("bhqd,bhkd->bhqk", q, k) * (D ** -0.5)
        off = Sk - Sq
        qi = torch.arange(Sq)[:, None]
        kj = torch.arange(Sk)[None, :]
        cmask = kj <= (qi + off)
        scores = torch.where(cmask[None, None], scores, -1e9)
        p = _softmax(scores, axis=-1)
        ctx = torch.einsum("bhqk,bhkd->bhqd", p, v)
        return torch.einsum("bhqd,hdm->bqm", ctx, w_o)

    def _B_ref(x, w1, b1, w2, b2):
        h = torch.einsum("bsd,df->bsf", x, w1) + b1
        h = _gelu(h)
        return torch.einsum("bsf,fd->bsd", h, w2) + b2

    x = A_x
    xn = _layernorm(x, axis=-1)
    s = _A_ref(xn, A_c_kv, A_w_q, A_w_uk, A_w_uv, A_w_o)
    g = _silu(_B_ref(xn, B_w1, B_b1, B_w2, B_b2))
    return x + s * g
```

```asm
; @launch grid=(256,1,1) block=(256,1,1) lds=124032
.amdgcn_target "amdgcn-amd-amdhsa--gfx950"
.text
.globl recurrent_scan__compressed_kv_cla__dense_activation_gelu__decode_kernel
.p2align 8
.type recurrent_scan__compressed_kv_cla__dense_activation_gelu__decode_kernel,@function
recurrent_scan__compressed_kv_cla__dense_activation_gelu__decode_kernel:
    s_cmpk_ge_u32 s2, 256
    s_cbranch_scc1 L_exit
    s_load_dwordx2 s[4:5], s[0:1], 0
    s_load_dwordx2 s[8:9], s[0:1], 16
    s_load_dwordx2 s[12:13], s[0:1], 24
    s_load_dwordx2 s[16:17], s[0:1], 104
    s_getpc_b64 s[30:31]
L_pc:
    s_lshr_b32 s25, s2, 3
    v_lshlrev_b32_e64 v5, 7, v0
    v_min_u32 v5, L_codeend-L_pc-4, v5
    global_load_dword v255, v5, s[30:31]
    s_cmp_lt_u32 s25, 16
    s_cbranch_scc1 L_A
    s_cmp_ge_u32 s25, 28
    s_cbranch_scc1 L_F
    v_lshrrev_b32_e64 v2, 6, v0
    v_and_b32 v1, 63, v0
    v_readfirstlane_b32 s3, v2
    s_and_b32 s24, s2, 3
    s_bfe_u32 s27, s2, 0x10002
    s_lshl1_add_u32 s24, s24, s27
    s_mov_b32 s18, 268435456
    s_mov_b32 s19, 0x20000
    s_mov_b32 s14, 9437184
    s_mov_b32 s15, 0x20000
    s_sub_u32 s25, s25, 16
    v_lshrrev_b32 v2, 3, v1
    v_and_b32 v5, 7, v1
    v_lshrrev_b32 v4, 5, v1
    v_and_b32_e64 v3, 3, v2
    v_lshl_add_u32 v4, v4, 3, v3
    v_mul_u32_u24 v4, 12288, v4
    v_lshrrev_b32 v3, 1, v2
    v_xor_b32 v3, v3, v5
    v_lshl_add_u32 v6, v3, 4, v4
    v_xor_b32_e64 v7, 64, v6
    v_add_u32 v7, 196608, v7
    s_mul_i32 s35, s25, 786432
    s_lshl_b32 s36, s24, 2
    s_add_u32 s36, s36, s3
    s_mul_i32 s27, s36, 384
    s_add_u32 s35, s35, s27
    s_mul_i32 s37, s3, 24608
    s_mov_b32 m0, s37
    s_movk_i32 s38, 896
    s_movk_i32 s39, 1280
    s_mov_b32 s40, 49152
    s_mul_i32 s27, s25, 12
    v_lshrrev_b32 v8, 3, v0
    v_min_u32 v8, 11, v8
    v_add_u32 v8, s27, v8
    v_min_u32 v8, 127, v8
    v_lshlrev_b32_e64 v8, 7, v8
    s_mul_i32 s42, s24, 16384
    s_add_u32 s42, s42, 2686976
    s_waitcnt lgkmcnt(0)
    buffer_load_dwordx4 v6, s[12:15], s35 offen offset:0 nt lds
    s_add_u32 m0, m0, s38
    s_nop 0
    buffer_load_dwordx4 v6, s[12:15], s35 offen offset:128 nt lds
    s_add_u32 m0, m0, s38
    buffer_load_dword v17, v8, s[16:19], s42 offen sc1
    buffer_load_dwordx4 v6, s[12:15], s35 offen offset:256 nt lds
    s_add_u32 m0, m0, s39
    s_nop 0
    buffer_load_dwordx4 v7, s[12:15], s35 offen offset:0 nt lds
    s_add_u32 m0, m0, s38
    s_nop 0
    buffer_load_dwordx4 v7, s[12:15], s35 offen offset:128 nt lds
    s_add_u32 m0, m0, s38
    s_nop 0
    buffer_load_dwordx4 v7, s[12:15], s35 offen offset:256 nt lds
    s_add_u32 m0, m0, s39
    s_add_u32 s35, s35, s40
    s_xor_b32 s40, s40, 360448
    s_load_dword s26, s[16:17], 0
    s_load_dwordx2 s[30:31], s[0:1], 96
    s_load_dwordx2 s[8:9], s[0:1], 32
    s_load_dwordx2 s[20:21], s[0:1], 40
    v_lshlrev_b32 v10, 4, v1
    v_and_b32 v3, 1, v1
    v_lshlrev_b32_e64 v3, 4, v3
    v_mov_b32 v4, 0xffff
    v_lshlrev_b32_e64 v3, v3, v4
    v_bfe_u32 v4, v1, 1, 2
    v_cmp_eq_u32 vcc, 0, v4
    s_nop 1
    v_cndmask_b32 v152, 0, v3, vcc
    v_cmp_eq_u32 vcc, 1, v4
    s_nop 1
    v_cndmask_b32 v153, 0, v3, vcc
    v_cmp_eq_u32 vcc, 2, v4
    s_nop 1
    v_cndmask_b32 v154, 0, v3, vcc
    v_cmp_eq_u32 vcc, 3, v4
    s_nop 1
    v_cndmask_b32 v155, 0, v3, vcc
    v_and_b32 v2, 15, v1
    v_lshrrev_b32 v3, 4, v1
    v_lshrrev_b32_e64 v4, 3, v2
    v_mul_u32_u24 v4, 3072, v4
    v_and_b32_e64 v5, 7, v2
    v_lshl_add_u32 v4, v5, 7, v4
    v_lshrrev_b32 v5, 1, v2
    v_xor_b32 v5, v5, v3
    v_lshl_add_u32 v4, v5, 4, v4
    v_add_u32_e64 v8, s37, v4
    v_xad_u32 v9, v4, 64, s37
    s_mul_i32 s41, s36, 4096
    s_add_u32 s41, s41, 2686976
    s_add_u32 s45, s41, 4096
    s_lshl_b32 s27, s3, 9
    s_add_u32 s27, s27, 110720
    v_lshl_add_u32 v11, v1, 1, s27
    v_lshl_add_u32 v12, v3, 4, s27
    v_lshrrev_b32 v4, 1, v3
    v_lshl_add_u32 v4, v2, 1, v4
    v_lshlrev_b32 v4, 10, v4
    v_and_b32 v5, 1, v3
    v_lshl_add_u32 v13, v5, 6, v4
    s_lshl_b32 s42, s25, 12
    s_lshl_b32 s27, s24, 7
    s_add_u32 s42, s42, s27
    s_lshl_b32 s27, s3, 4
    s_add_u32 s42, s42, s27
    s_add_u32 s42, s42, 1245184
    v_and_b32 v4, 15, v1
    v_lshlrev_b32 v4, 5, v4
    v_and_b32 v5, 16, v1
    s_mul_i32 s27, s3, 2560
    s_add_u32 s27, s27, 112768
    v_add3_u32 v156, v4, v5, s27
    s_mul_i32 s27, s3, 640
    v_lshl_add_u32 v158, v1, 4, s27
    v_add_u32 v157, 112768, v158
    v_mul_u32_u24 v4, 1280, v3
    v_lshl_add_u32 v159, v2, 4, v4
    v_lshlrev_b32 v4, 10, v2
    v_lshl_add_u32 v160, v3, 4, v4
    s_lshr_b32 s87, s25, 2
    s_lshl_b32 s27, s24, 2
    s_add_u32 s87, s87, s27
    s_and_b32 s27, s25, 3
    s_lshl_b32 s27, s27, 2
    s_add_u32 s27, s27, s3
    s_mul_i32 s84, s87, 48
    s_add_u32 s84, s84, s27
    s_mulk_i32 s84, 5120
    s_add_u32 s85, s84, 81920
    s_add_u32 s86, s84, 163840
    s_mulk_i32 s87, 12288
    s_lshl_b32 s27, s27, 6
    s_add_u32 s87, s87, s27
    s_add_u32 s87, s87, 851968
    s_lshl_b32 s88, s24, 4
    s_add_u32 s88, s88, s25
    s_lshl_b32 s83, s3, 13
    s_add_u32 s83, s83, 1376256
    s_mulk_i32 s88, 2560
    s_add_u32 s88, s88, 2228224
    v_mov_b32 v164, 0
    v_mov_b32 v165, 0
    v_mov_b32 v166, 0
    v_mov_b32 v161, 1
    s_and_b32 s28, s25, 3
    s_xor_b32 s28, s28, 3
    s_lshr_b32 s27, s3, 0
    s_or_b32 s28, s28, s27
    v_lshlrev_b32 v4, 7, v1
    s_cmp_eq_u32 s28, 0
    s_cselect_b32 s27, 40, 0
    v_cmp_gt_u32_e64 vcc, s27, v1
    v_mov_b32 v162, 0x20000000
    s_nop 0
    v_cndmask_b32 v162, v162, v4, vcc
    v_mov_b32 v163, v10
    v_lshlrev_b32 v4, 9, v1
    s_cmp_eq_u32 s3, 0
    s_cselect_b32 s27, 32, 0
    v_cmp_gt_u32 vcc, s27, v1
    v_mov_b32 v150, 0x20000000
    s_nop 0
    v_cndmask_b32 v150, v150, v4, vcc
    s_lshr_b32 s82, s24, 1
    s_lshl_b32 s82, s82, 7
    s_add_u32 s82, s82, 1294336
    s_waitcnt lgkmcnt(0)
    s_mul_i32 s26, s26, 0x9e3779b1
    s_add_u32 s26, s26, 0x7f4a7c15
    s_mov_b32 s10, 9437184
    s_mov_b32 s11, 0x20000
    s_mov_b32 s22, 7864320
    s_mov_b32 s23, 0x20000
    s_waitcnt vmcnt(5)
    buffer_load_dwordx4 v6, s[12:15], s35 offen offset:0 nt lds
    s_add_u32 m0, m0, s38
    s_waitcnt vmcnt(5)
    buffer_load_dwordx4 v6, s[12:15], s35 offen offset:128 nt lds
    s_add_u32 m0, m0, s38
    s_waitcnt vmcnt(5)
    buffer_load_dwordx4 v6, s[12:15], s35 offen offset:256 nt lds
    s_add_u32 m0, m0, s39
    s_waitcnt vmcnt(5)
    buffer_load_dwordx4 v7, s[12:15], s35 offen offset:0 nt lds
    s_add_u32 m0, m0, s38
    s_waitcnt vmcnt(5)
    buffer_load_dwordx4 v7, s[12:15], s35 offen offset:128 nt lds
    s_add_u32 m0, m0, s38
    s_waitcnt vmcnt(5)
    buffer_load_dwordx4 v7, s[12:15], s35 offen offset:256 nt lds
    s_add_u32 m0, m0, s39
    s_add_u32 s35, s35, s40
    s_xor_b32 s40, s40, 360448
    s_waitcnt vmcnt(5)
    buffer_load_dwordx4 v6, s[12:15], s35 offen offset:0 nt lds
    s_add_u32 m0, m0, s38
    s_waitcnt vmcnt(5)
    buffer_load_dwordx4 v6, s[12:15], s35 offen offset:128 nt lds
    s_add_u32 m0, m0, s38
    s_waitcnt vmcnt(5)
    buffer_load_dwordx4 v6, s[12:15], s35 offen offset:256 nt lds
    s_add_u32 m0, m0, s39
    s_waitcnt vmcnt(5)
    buffer_load_dwordx4 v7, s[12:15], s35 offen offset:0 nt lds
    s_add_u32 m0, m0, s38
    s_waitcnt vmcnt(5)
    buffer_load_dwordx4 v7, s[12:15], s35 offen offset:128 nt lds
    s_add_u32 m0, m0, s38
    s_waitcnt vmcnt(5)
    buffer_load_dwordx4 v7, s[12:15], s35 offen offset:256 nt lds
    s_add_u32 m0, m0, s39
    s_add_u32 s35, s35, s40
    s_xor_b32 s40, s40, 360448
    s_waitcnt vmcnt(5)
    buffer_load_dwordx4 v6, s[12:15], s35 offen offset:0 nt lds
    s_add_u32 m0, m0, s38
    s_waitcnt vmcnt(5)
    buffer_load_dwordx4 v6, s[12:15], s35 offen offset:128 nt lds
    s_add_u32 m0, m0, s38
    s_waitcnt vmcnt(5)
    buffer_load_dwordx4 v6, s[12:15], s35 offen offset:256 nt lds
    s_add_u32 m0, m0, s39
    s_waitcnt vmcnt(5)
    buffer_load_dwordx4 v7, s[12:15], s35 offen offset:0 nt lds
    s_add_u32 m0, m0, s38
    s_waitcnt vmcnt(5)
    buffer_load_dwordx4 v7, s[12:15], s35 offen offset:128 nt lds
    s_add_u32 m0, m0, s38
    s_waitcnt vmcnt(5)
    buffer_load_dwordx4 v7, s[12:15], s35 offen offset:256 nt lds
    s_add_u32 m0, m0, s39
    ds_read_b128 a[0:3], v8 offset:0
    ds_read_b128 a[4:7], v9 offset:0
    ds_read_b128 a[8:11], v8 offset:1024
    ds_read_b128 a[12:15], v9 offset:1024
    ds_read_b128 a[16:19], v8 offset:2048
    ds_read_b128 a[20:23], v9 offset:2048
    ds_read_b128 a[24:27], v8 offset:6144
    ds_read_b128 a[28:31], v9 offset:6144
    ds_read_b128 a[32:35], v8 offset:7168
    ds_read_b128 a[36:39], v9 offset:7168
    ds_read_b128 a[40:43], v8 offset:8192
    ds_read_b128 a[44:47], v9 offset:8192
    ds_read_b128 a[48:51], v8 offset:12288
    ds_read_b128 a[52:55], v9 offset:12288
    ds_read_b128 a[56:59], v8 offset:13312
    ds_read_b128 a[60:63], v9 offset:13312
    ds_read_b128 a[64:67], v8 offset:14336
    ds_read_b128 a[68:71], v9 offset:14336
    s_waitcnt vmcnt(3)
    buffer_load_dwordx4 v[16:19], v10, s[16:19], s41 offen offset:0 sc1
    buffer_load_dwordx4 v[20:23], v10, s[16:19], s41 offen offset:1024 sc1
    buffer_load_dwordx4 v[24:27], v10, s[16:19], s41 offen offset:2048 sc1
    buffer_load_dwordx4 v[28:31], v10, s[16:19], s41 offen offset:3072 sc1
    s_load_dword s92, s[30:31], 0
    s_waitcnt vmcnt(4)
    ds_read_b128 a[72:75], v8 offset:18432
    ds_read_b128 a[76:79], v9 offset:18432
    ds_read_b128 a[80:83], v8 offset:19456
    ds_read_b128 a[84:87], v9 offset:19456
    ds_read_b128 a[88:91], v8 offset:20480
    ds_read_b128 a[92:95], v9 offset:20480
    s_waitcnt vmcnt(0) lgkmcnt(0)
    s_cmp_lt_u32 s92, 32
    s_cbranch_scc1 L_H_fslow
L_H_fok:
    v_min3_u32 v4, s26, v19, v23
    v_max3_u32 v5, s26, v19, v23
    v_min3_u32 v4, v4, v27, v31
    v_max3_u32 v5, v5, v27, v31
    v_cmp_ne_u32 vcc, v4, v5
    s_cbranch_vccnz L_H_xq_slow
L_H_xq_ok:
    v_add_f32 v16, v16, v20
    v_add_f32 v24, v24, v28
    v_add_f32 v17, v17, v21
    v_add_f32 v25, v25, v29
    v_add_f32 v18, v18, v22
    v_add_f32 v26, v26, v30
    v_add_f32 v16, v16, v24
    v_add_f32 v17, v17, v25
    v_add_f32 v18, v18, v26
    v_cvt_pk_bf16_f32 v16, v16, v17
    v_cvt_pk_bf16_f32 v18, v18, v18
    ds_write_b16 v11, v16
    ds_write_b16_d16_hi v11, v16 offset:128
    ds_write_b16 v11, v18 offset:256
    ds_read_b128 v[32:35], v12 offset:0
    ds_read_b128 v[36:39], v12 offset:64
    ds_read_b128 v[40:43], v12 offset:128
    ds_read_b128 v[44:47], v12 offset:192
    ds_read_b128 v[48:51], v12 offset:256
    ds_read_b128 v[52:55], v12 offset:320
    s_waitcnt lgkmcnt(5)
    v_mfma_f32_16x16x32_bf16 v[16:19], a[0:3], v[32:35], 0
    v_mfma_f32_16x16x32_bf16 v[20:23], a[24:27], v[32:35], 0
    v_mfma_f32_16x16x32_bf16 v[24:27], a[48:51], v[32:35], 0
    v_mfma_f32_16x16x32_bf16 v[28:31], a[72:75], v[32:35], 0
    s_waitcnt lgkmcnt(4)
    v_mfma_f32_16x16x32_bf16 v[16:19], a[4:7], v[36:39], v[16:19]
    v_mfma_f32_16x16x32_bf16 v[20:23], a[28:31], v[36:39], v[20:23]
    v_mfma_f32_16x16x32_bf16 v[24:27], a[52:55], v[36:39], v[24:27]
    v_mfma_f32_16x16x32_bf16 v[28:31], a[76:79], v[36:39], v[28:31]
    s_waitcnt lgkmcnt(3)
    v_mfma_f32_16x16x32_bf16 v[16:19], a[8:11], v[40:43], v[16:19]
    v_mfma_f32_16x16x32_bf16 v[20:23], a[32:35], v[40:43], v[20:23]
    v_mfma_f32_16x16x32_bf16 v[24:27], a[56:59], v[40:43], v[24:27]
    v_mfma_f32_16x16x32_bf16 v[28:31], a[80:83], v[40:43], v[28:31]
    s_waitcnt lgkmcnt(2)
    v_mfma_f32_16x16x32_bf16 v[16:19], a[12:15], v[44:47], v[16:19]
    v_mfma_f32_16x16x32_bf16 v[20:23], a[36:39], v[44:47], v[20:23]
    v_mfma_f32_16x16x32_bf16 v[24:27], a[60:63], v[44:47], v[24:27]
    v_mfma_f32_16x16x32_bf16 v[28:31], a[84:87], v[44:47], v[28:31]
    s_waitcnt lgkmcnt(1)
    v_mfma_f32_16x16x32_bf16 v[16:19], a[16:19], v[48:51], v[16:19]
    v_mfma_f32_16x16x32_bf16 v[20:23], a[40:43], v[48:51], v[20:23]
    v_mfma_f32_16x16x32_bf16 v[24:27], a[64:67], v[48:51], v[24:27]
    v_mfma_f32_16x16x32_bf16 v[28:31], a[88:91], v[48:51], v[28:31]
    s_waitcnt lgkmcnt(0)
    v_mfma_f32_16x16x32_bf16 v[16:19], a[20:23], v[52:55], v[16:19]
    v_mfma_f32_16x16x32_bf16 v[20:23], a[44:47], v[52:55], v[20:23]
    v_mfma_f32_16x16x32_bf16 v[24:27], a[68:71], v[52:55], v[24:27]
    v_mfma_f32_16x16x32_bf16 v[28:31], a[92:95], v[52:55], v[28:31]
    s_barrier
    buffer_atomic_add v161, v150, s[16:19], s82 offen sc1
    v_cmp_eq_u32 vcc, 1, v2
    s_mov_b32 s27, 0x3dd53b95
    s_mov_b32 exec_lo, 0x30003
    s_mov_b32 exec_hi, 0x30003
    s_nop 0
    v_cndmask_b32 v16, v16, v24, vcc
    v_cndmask_b32 v17, v17, v25, vcc
    v_cndmask_b32 v18, v18, v26, vcc
    v_cndmask_b32 v19, v19, v27, vcc
    v_cndmask_b32 v20, v20, v28, vcc
    v_cndmask_b32 v21, v21, v29, vcc
    v_cndmask_b32 v22, v22, v30, vcc
    v_cndmask_b32 v23, v23, v31, vcc
    v_mul_f32 v16, s27, v16
    v_mul_f32 v17, s27, v17
    v_mul_f32 v18, s27, v18
    v_mul_f32 v19, s27, v19
    v_mul_f32 v20, s27, v20
    v_mul_f32 v21, s27, v21
    v_mul_f32 v22, s27, v22
    v_mul_f32_e64 v23, s27, v23
    v_cvt_pk_bf16_f32 v24, v16, v17
    v_cvt_pk_bf16_f32 v25, v18, v19
    v_cvt_pk_bf16_f32 v26, v20, v21
    v_cvt_pk_bf16_f32 v27, v22, v23
    v_min_u32_e64 v27, -2, v27
    buffer_store_dwordx4 v[24:27], v13, s[16:19], s42 offen sc1
    s_mov_b64 exec, -1
    s_barrier
    s_cmp_lt_u32 s25, 8
    s_cselect_b32 s44, 16, 4
    s_cselect_b32 s47, 4, 8
    s_cselect_b32 s40, 8, 48
    s_cselect_b32 s46, 393216, 0
    s_cselect_b32 s27, 1, 2
    s_cselect_b32 s28, 0, 393216
    s_mulk_i32 s47, 12288
    s_mulk_i32 s40, 12288
    s_and_b32 s35, s25, 7
    s_mul_i32 s35, s35, s27
    s_mul_i32 s35, s35, 1179648
    s_add_u32 s35, s35, s28
    s_mul_i32 s27, s36, 384
    s_add_u32 s35, s35, s27
    v_lshrrev_b32 v4, 5, v1
    v_bfe_u32 v5, v1, 3, 2
    v_mad_u32_u24 v4, v4, s44, v5
    v_mul_u32_u24 v4, 12288, v4
    v_and_b32 v5, 2, v5
    v_xor_b32 v5, v5, v1
    v_and_b32 v5, 7, v5
    v_lshl_add_u32 v6, v5, 4, v4
    v_xad_u32 v7, v6, 64, s47
    s_mov_b32 m0, s37
    s_getreg_b32 s80, hwreg(HW_REG_XCC_ID, 0, 4)
    s_lshl_b32 s80, s80, 2
    s_lshl_b32 s93, s24, 7
    s_add_u32 s80, s80, s93
    s_add_u32 s80, s80, 1310720
    s_cmp_lg_u32 s3, 0
    s_cbranch_scc1 L_H_nocensus
    s_mov_b32 s93, 1
    s_atomic_add s93, s[16:17], s80
L_H_nocensus:
    buffer_load_dwordx4 v6, s[8:11], s35 offen offset:0 nt lds
    s_add_u32 m0, m0, s38
    s_nop 0
    buffer_load_dwordx4 v6, s[8:11], s35 offen offset:128 nt lds
    s_add_u32 m0, m0, s38
    s_waitcnt vmcnt(3)
    buffer_load_dwordx4 v6, s[8:11], s35 offen offset:256 nt lds
    s_add_u32 m0, m0, s39
    s_waitcnt vmcnt(3)
    buffer_load_dwordx4 v7, s[8:11], s35 offen offset:0 nt lds
    s_add_u32 m0, m0, s38
    s_waitcnt vmcnt(3)
    buffer_load_dwordx4 v7, s[8:11], s35 offen offset:128 nt lds
    s_add_u32 m0, m0, s38
    s_nop 0
    buffer_load_dwordx4 v7, s[8:11], s35 offen offset:256 nt lds
    s_add_u32 m0, m0, s39
    s_add_u32 s35, s35, s40
    s_xor_b32 s40, s40, s46
    buffer_load_dwordx4 v6, s[8:11], s35 offen offset:0 nt lds
    s_add_u32 m0, m0, s38
    s_nop 0
    buffer_load_dwordx4 v6, s[8:11], s35 offen offset:128 nt lds
    s_add_u32 m0, m0, s38
    s_nop 0
    buffer_load_dwordx4 v6, s[8:11], s35 offen offset:256 nt lds
    s_add_u32 m0, m0, s39
    s_waitcnt vmcnt(7)
    buffer_load_dwordx4 v7, s[8:11], s35 offen offset:0 nt lds
    s_add_u32 m0, m0, s38
    s_waitcnt vmcnt(7)
    buffer_load_dwordx4 v7, s[8:11], s35 offen offset:128 nt lds
    s_add_u32 m0, m0, s38
    s_waitcnt vmcnt(7)
    buffer_load_dwordx4 v7, s[8:11], s35 offen offset:256 nt lds
    s_add_u32 m0, m0, s39
    s_add_u32 s35, s35, s40
    s_xor_b32 s40, s40, s46
    s_waitcnt vmcnt(7)
    buffer_load_dwordx4 v6, s[8:11], s35 offen offset:0 nt lds
    s_add_u32 m0, m0, s38
    s_waitcnt vmcnt(7)
    buffer_load_dwordx4 v6, s[8:11], s35 offen offset:128 nt lds
    s_add_u32 m0, m0, s38
    s_waitcnt vmcnt(7)
    buffer_load_dwordx4 v6, s[8:11], s35 offen offset:256 nt lds
    s_add_u32 m0, m0, s39
    s_waitcnt vmcnt(7)
    buffer_load_dwordx4 v7, s[8:11], s35 offen offset:0 nt lds
    s_add_u32 m0, m0, s38
    s_waitcnt vmcnt(7)
    buffer_load_dwordx4 v7, s[8:11], s35 offen offset:128 nt lds
    s_add_u32 m0, m0, s38
    s_waitcnt vmcnt(7)
    buffer_load_dwordx4 v7, s[8:11], s35 offen offset:256 nt lds
    s_add_u32 m0, m0, s39
    s_add_u32 s35, s35, s40
    s_xor_b32 s40, s40, s46
    s_waitcnt vmcnt(7)
    buffer_load_dwordx4 v6, s[8:11], s35 offen offset:0 nt lds
    s_add_u32 m0, m0, s38
    s_waitcnt vmcnt(7)
    buffer_load_dwordx4 v6, s[8:11], s35 offen offset:128 nt lds
    s_add_u32 m0, m0, s38
    s_waitcnt vmcnt(7)
    buffer_load_dwordx4 v6, s[8:11], s35 offen offset:256 nt lds
    s_add_u32 m0, m0, s39
    s_waitcnt vmcnt(7)
    buffer_load_dwordx4 v7, s[8:11], s35 offen offset:0 nt lds
    s_add_u32 m0, m0, s38
    s_waitcnt vmcnt(7)
    buffer_load_dwordx4 v7, s[8:11], s35 offen offset:128 nt lds
    s_add_u32 m0, m0, s38
    s_waitcnt vmcnt(7)
    buffer_load_dwordx4 v7, s[8:11], s35 offen offset:256 nt lds
    s_add_u32 m0, m0, s39
    v_mul_u32_u24 v4, 3072, v3
    v_lshrrev_b32 v5, 2, v2
    v_lshl_add_u32 v4, v5, 7, v4
    v_and_b32 v5, 2, v5
    v_and_b32 v12, 1, v3
    v_lshl_or_b32 v5, v12, 2, v5
    v_bfe_u32 v12, v1, 1, 1
    v_or_b32_e64 v5, v5, v12
    v_lshl_add_u32 v4, v5, 4, v4
    v_and_b32_e64 v12, 1, v1
    v_lshl_add_u32 v4, v12, 3, v4
    v_add_u32_e64 v8, s37, v4
    v_xad_u32 v9, v4, 32, s37
    v_xad_u32 v14, v4, 64, s37
    v_xor_b32_e64 v4, 64, v4
    v_xad_u32 v15, v4, 32, s37
    v_lshrrev_b32 v5, 3, v1
    v_lshrrev_b32 v4, 1, v5
    v_xor_b32 v4, v4, v1
    v_and_b32 v4, 7, v4
    v_lshlrev_b32_e64 v4, 4, v4
    v_mul_u32_u24 v5, 1536, v5
    v_add_u32 v24, v4, v5
    v_xor_b32 v4, 64, v4
    v_add_u32 v4, 12288, v4
    v_add_u32_e64 v25, v4, v5
    s_mul_i32 s40, s36, 24576
    s_lshl_b32 s27, s25, 7
    s_add_u32 s40, s40, s27
    s_add_u32 s40, s40, 1441792
    s_lshl_b32 s41, s3, 11
    s_add_u32 s41, s41, 100480
    v_lshrrev_b32 v4, 1, v2
    v_xor_b32 v4, v4, v3
    v_lshlrev_b32 v4, 4, v4
    v_lshl_add_u32 v5, v2, 7, s41
    v_add_u32_e64 v26, v4, v5
    v_xad_u32 v27, v4, 64, v5
    v_lshrrev_b32_e64 v36, 2, v1
    v_lshlrev_b32 v36, 8, v36
    s_lshl_b32 s27, s25, 1
    s_sub_u32 s27, s27, 16
    s_cmp_lt_u32 s25, 8
    s_cselect_b32 s27, s25, s27
    s_cselect_b32 s89, 0, 128
    s_lshl_b32 s42, s27, 12
    s_lshl_b32 s28, s36, 3
    s_add_u32 s42, s42, s28
    s_add_u32 s42, s42, 1409024
    s_lshl_b32 s28, s24, 3
    s_add_u32 s27, s27, s28
    s_lshl_b32 s27, s27, 7
    s_add_u32 s27, s27, 1343488
    s_add_u32 s90, s16, s27
    s_addc_u32 s91, s17, 0
    s_mul_i32 s43, s36, 12
    s_add_u32 s43, s43, s25
    s_lshl_b32 s43, s43, 10
    s_add_u32 s43, s43, 851968
    v_mov_b32 v31, s26
    ds_read_b64_tr_b16 a[0:1], v8 offset:0
    ds_read_b64_tr_b16 a[2:3], v8 offset:512
    ds_read_b64_tr_b16 a[8:9], v9 offset:0
    ds_read_b64_tr_b16 a[10:11], v9 offset:512
    ds_read_b64_tr_b16 a[16:17], v14 offset:0
    ds_read_b64_tr_b16 a[18:19], v14 offset:512
    ds_read_b64_tr_b16 a[24:25], v15 offset:0
    ds_read_b64_tr_b16 a[26:27], v15 offset:512
    ds_read_b64_tr_b16 a[32:33], v8 offset:1024
    ds_read_b64_tr_b16 a[34:35], v8 offset:1536
    ds_read_b64_tr_b16 a[40:41], v9 offset:1024
    ds_read_b64_tr_b16 a[42:43], v9 offset:1536
    ds_read_b64_tr_b16 a[48:49], v14 offset:1024
    ds_read_b64_tr_b16 a[50:51], v14 offset:1536
    ds_read_b64_tr_b16 a[56:57], v15 offset:1024
    ds_read_b64_tr_b16 a[58:59], v15 offset:1536
    ds_read_b64_tr_b16 a[64:65], v8 offset:2048
    ds_read_b64_tr_b16 a[66:67], v8 offset:2560
    ds_read_b64_tr_b16 a[72:73], v9 offset:2048
    ds_read_b64_tr_b16 a[74:75], v9 offset:2560
    ds_read_b64_tr_b16 a[80:81], v14 offset:2048
    ds_read_b64_tr_b16 a[82:83], v14 offset:2560
    ds_read_b64_tr_b16 a[88:89], v15 offset:2048
    ds_read_b64_tr_b16 a[90:91], v15 offset:2560
    s_waitcnt vmcnt(7)
    buffer_load_dwordx4 a[192:195], v159, s[20:23], s84 offen offset:0 nt
    s_waitcnt vmcnt(7)
    buffer_load_dwordx4 a[196:199], v159, s[20:23], s84 offen offset:256 nt
    s_waitcnt vmcnt(7)
    buffer_load_dwordx4 a[200:203], v159, s[20:23], s84 offen offset:512 nt
    s_waitcnt vmcnt(7)
    buffer_load_dwordx4 a[204:207], v159, s[20:23], s84 offen offset:768 nt
    s_waitcnt vmcnt(7)
    buffer_load_dwordx4 a[208:211], v159, s[20:23], s84 offen offset:1024 nt
    s_waitcnt vmcnt(7)
    buffer_load_dwordx4 a[212:215], v159, s[20:23], s85 offen offset:0 nt
    s_waitcnt vmcnt(7)
    buffer_load_dwordx4 a[216:219], v159, s[20:23], s85 offen offset:256 nt
    s_waitcnt vmcnt(7)
    buffer_load_dwordx4 a[220:223], v159, s[20:23], s85 offen offset:512 nt
    s_waitcnt vmcnt(7)
    buffer_load_dwordx4 a[224:227], v159, s[20:23], s85 offen offset:768 nt
    s_waitcnt vmcnt(7)
    buffer_load_dwordx4 a[228:231], v159, s[20:23], s85 offen offset:1024 nt
    s_waitcnt vmcnt(7)
    buffer_load_dwordx4 a[232:235], v159, s[20:23], s86 offen offset:0 nt
    s_waitcnt vmcnt(7)
    buffer_load_dwordx4 a[236:239], v159, s[20:23], s86 offen offset:256 nt
    s_waitcnt vmcnt(7)
    buffer_load_dwordx4 a[240:243], v159, s[20:23], s86 offen offset:512 nt
    s_waitcnt vmcnt(7)
    buffer_load_dwordx4 a[244:247], v159, s[20:23], s86 offen offset:768 nt
    s_waitcnt vmcnt(7)
    buffer_load_dwordx4 a[248:251], v159, s[20:23], s86 offen offset:1024 nt
    s_load_dword s80, s[16:17], s80
    s_load_dword s92, s[30:31], 128
    ds_read_b64_tr_b16 a[4:5], v8 offset:12288
    ds_read_b64_tr_b16 a[6:7], v8 offset:12800
    ds_read_b64_tr_b16 a[12:13], v9 offset:12288
    ds_read_b64_tr_b16 a[14:15], v9 offset:12800
    ds_read_b64_tr_b16 a[20:21], v14 offset:12288
    ds_read_b64_tr_b16 a[22:23], v14 offset:12800
    ds_read_b64_tr_b16 a[28:29], v15 offset:12288
    ds_read_b64_tr_b16 a[30:31], v15 offset:12800
    ds_read_b64_tr_b16 a[36:37], v8 offset:13312
    ds_read_b64_tr_b16 a[38:39], v8 offset:13824
    ds_read_b64_tr_b16 a[44:45], v9 offset:13312
    ds_read_b64_tr_b16 a[46:47], v9 offset:13824
    ds_read_b64_tr_b16 a[52:53], v14 offset:13312
    ds_read_b64_tr_b16 a[54:55], v14 offset:13824
    ds_read_b64_tr_b16 a[60:61], v15 offset:13312
    ds_read_b64_tr_b16 a[62:63], v15 offset:13824
    ds_read_b64_tr_b16 a[68:69], v8 offset:14336
    ds_read_b64_tr_b16 a[70:71], v8 offset:14848
    ds_read_b64_tr_b16 a[76:77], v9 offset:14336
    ds_read_b64_tr_b16 a[78:79], v9 offset:14848
    ds_read_b64_tr_b16 a[84:85], v14 offset:14336
    ds_read_b64_tr_b16 a[86:87], v14 offset:14848
    ds_read_b64_tr_b16 a[92:93], v15 offset:14336
    ds_read_b64_tr_b16 a[94:95], v15 offset:14848
    s_waitcnt lgkmcnt(0)
    s_cmp_lt_u32 s92, 32
    s_cbranch_scc1 L_H1_fslow
L_H1_fok:
    s_cmp_lg_u32 s3, 0
    s_cbranch_scc1 L_H_n3_out
    s_mov_b32 s28, 0
L_H_n3:
    s_load_dword s92, s[90:91], 0 glc
    s_load_dword s93, s[90:91], s89 glc
    s_add_u32 s28, s28, 1
    s_cmp_ge_u32 s28, 200000
    s_waitcnt lgkmcnt(0)
    s_cbranch_scc1 L_H_n3_out
    s_min_i32 s27, s92, s93
    s_cmp_lt_i32 s27, 15
    s_cbranch_scc1 L_H_n3
L_H_n3_out:
    s_barrier
    s_mov_b32 s28, 0
    s_mov_b32 m0, s41
    s_add_u32 s28, s28, 1
    buffer_load_dwordx4 v24, s[16:19], s40 offen sc1 lds
    s_add_u32 m0, m0, 1024
    s_nop 0
    buffer_load_dwordx4 v25, s[16:19], s40 offen sc1 lds
    buffer_load_dwordx2 v[40:41], v36, s[16:19], s42 offen sc1
    s_waitcnt vmcnt(1)
L_H_x3:
    ds_read_b128 v[48:51], v26
    ds_read_b128 v[52:55], v27
    s_waitcnt vmcnt(0)
    v_max_f32 v4, v40, v40 row_ror:4 row_mask:0xf bank_mask:0xf
    s_nop 1
    v_max_f32 v4, v4, v4 row_ror:8 row_mask:0xf bank_mask:0xf
    v_mov_b32 v5, v4
    s_nop 1
    v_permlane32_swap_b32 v4, v5
    v_max_f32 v4, v4, v5
    v_mov_b32 v5, v4
    s_nop 1
    v_permlane16_swap_b32 v4, v5
    v_max_f32 v4, v4, v5
    v_sub_f32_e64 v16, v40, v4
    v_exp_f32 v16, v16
    s_waitcnt lgkmcnt(0)
    v_mfma_f32_16x16x32_bf16 v[64:67], v[48:51], a[0:3], 0
    v_max3_u32 v39, v41, v49, v51
    v_max3_u32 v39, v39, v53, v55
    v_mfma_f32_16x16x32_bf16 v[64:67], v[52:55], a[4:7], v[64:67]
    v_cmp_eq_u32 vcc, -1, v39
    s_cbranch_vccnz L_H_x3_retry
L_H_x3_ok:
    v_mfma_f32_16x16x32_bf16 v[68:71], v[48:51], a[8:11], 0
    v_mul_f32_e64 v17, v16, v41
    s_nop 1
    v_add_f32 v17, v17, v17 row_ror:4 row_mask:0xf bank_mask:0xf
    v_mfma_f32_16x16x32_bf16 v[68:71], v[52:55], a[12:15], v[68:71]
    s_nop 0
    v_add_f32 v17, v17, v17 row_ror:8 row_mask:0xf bank_mask:0xf
    v_mov_b32 v5, v17
    v_mfma_f32_16x16x32_bf16 v[72:75], v[48:51], a[16:19], 0
    v_mfma_f32_16x16x32_bf16 v[72:75], v[52:55], a[20:23], v[72:75]
    v_mfma_f32_16x16x32_bf16 v[76:79], v[48:51], a[24:27], 0
    v_mul_f32 v112, v16, v64 row_newbcast:0 row_mask:0xf bank_mask:0xf
    s_nop 0
    v_mul_f32 v113, v16, v68 row_newbcast:0 row_mask:0xf bank_mask:0xf
    v_mfma_f32_16x16x32_bf16 v[76:79], v[52:55], a[28:31], v[76:79]
    v_fmac_f32 v112, v16, v65 row_newbcast:4 row_mask:0xf bank_mask:0xf
    v_fmac_f32 v113, v16, v69 row_newbcast:4 row_mask:0xf bank_mask:0xf
    v_mfma_f32_16x16x32_bf16 v[80:83], v[48:51], a[32:35], 0
    v_fmac_f32 v112, v16, v66 row_newbcast:8 row_mask:0xf bank_mask:0xf
    v_fmac_f32 v113, v16, v70 row_newbcast:8 row_mask:0xf bank_mask:0xf
    v_mfma_f32_16x16x32_bf16 v[80:83], v[52:55], a[36:39], v[80:83]
    v_fmac_f32 v112, v16, v67 row_newbcast:12 row_mask:0xf bank_mask:0xf
    v_fmac_f32 v113, v16, v71 row_newbcast:12 row_mask:0xf bank_mask:0xf
    v_mfma_f32_16x16x32_bf16 v[84:87], v[48:51], a[40:43], 0
    v_mul_f32 v114, v16, v72 row_newbcast:0 row_mask:0xf bank_mask:0xf
    v_mul_f32 v115, v16, v76 row_newbcast:0 row_mask:0xf bank_mask:0xf
    v_mfma_f32_16x16x32_bf16 v[84:87], v[52:55], a[44:47], v[84:87]
    v_fmac_f32 v114, v16, v73 row_newbcast:4 row_mask:0xf bank_mask:0xf
    v_fmac_f32 v115, v16, v77 row_newbcast:4 row_mask:0xf bank_mask:0xf
    v_mfma_f32_16x16x32_bf16 v[88:91], v[48:51], a[48:51], 0
    v_fmac_f32 v114, v16, v74 row_newbcast:8 row_mask:0xf bank_mask:0xf
    v_fmac_f32 v115, v16, v78 row_newbcast:8 row_mask:0xf bank_mask:0xf
    v_mfma_f32_16x16x32_bf16 v[88:91], v[52:55], a[52:55], v[88:91]
    v_fmac_f32 v114, v16, v75 row_newbcast:12 row_mask:0xf bank_mask:0xf
    v_fmac_f32 v115, v16, v79 row_newbcast:12 row_mask:0xf bank_mask:0xf
    v_mfma_f32_16x16x32_bf16 v[92:95], v[48:51], a[56:59], 0
    v_mul_f32 v116, v16, v80 row_newbcast:0 row_mask:0xf bank_mask:0xf
    v_mul_f32 v117, v16, v84 row_newbcast:0 row_mask:0xf bank_mask:0xf
    v_mfma_f32_16x16x32_bf16 v[92:95], v[52:55], a[60:63], v[92:95]
    v_fmac_f32 v116, v16, v81 row_newbcast:4 row_mask:0xf bank_mask:0xf
    v_fmac_f32 v117, v16, v85 row_newbcast:4 row_mask:0xf bank_mask:0xf
    v_mfma_f32_16x16x32_bf16 v[96:99], v[48:51], a[64:67], 0
    v_fmac_f32 v116, v16, v82 row_newbcast:8 row_mask:0xf bank_mask:0xf
    v_fmac_f32 v117, v16, v86 row_newbcast:8 row_mask:0xf bank_mask:0xf
    v_mfma_f32_16x16x32_bf16 v[96:99], v[52:55], a[68:71], v[96:99]
    v_fmac_f32 v116, v16, v83 row_newbcast:12 row_mask:0xf bank_mask:0xf
    v_fmac_f32 v117, v16, v87 row_newbcast:12 row_mask:0xf bank_mask:0xf
    v_mfma_f32_16x16x32_bf16 v[100:103], v[48:51], a[72:75], 0
    v_mul_f32 v118, v16, v88 row_newbcast:0 row_mask:0xf bank_mask:0xf
    v_mul_f32 v119, v16, v92 row_newbcast:0 row_mask:0xf bank_mask:0xf
    v_mfma_f32_16x16x32_bf16 v[100:103], v[52:55], a[76:79], v[100:103]
    v_fmac_f32 v118, v16, v89 row_newbcast:4 row_mask:0xf bank_mask:0xf
    v_fmac_f32 v119, v16, v93 row_newbcast:4 row_mask:0xf bank_mask:0xf
    v_mfma_f32_16x16x32_bf16 v[104:107], v[48:51], a[80:83], 0
    v_fmac_f32 v118, v16, v90 row_newbcast:8 row_mask:0xf bank_mask:0xf
    v_fmac_f32 v119, v16, v94 row_newbcast:8 row_mask:0xf bank_mask:0xf
    v_mfma_f32_16x16x32_bf16 v[104:107], v[52:55], a[84:87], v[104:107]
    v_fmac_f32 v118, v16, v91 row_newbcast:12 row_mask:0xf bank_mask:0xf
    v_fmac_f32 v119, v16, v95 row_newbcast:12 row_mask:0xf bank_mask:0xf
    v_mfma_f32_16x16x32_bf16 v[108:111], v[48:51], a[88:91], 0
    v_mul_f32 v120, v16, v96 row_newbcast:0 row_mask:0xf bank_mask:0xf
    v_mul_f32 v121, v16, v100 row_newbcast:0 row_mask:0xf bank_mask:0xf
    v_mfma_f32_16x16x32_bf16 v[108:111], v[52:55], a[92:95], v[108:111]
    v_fmac_f32 v120, v16, v97 row_newbcast:4 row_mask:0xf bank_mask:0xf
    v_fmac_f32 v121, v16, v101 row_newbcast:4 row_mask:0xf bank_mask:0xf
    s_nop 0
    v_fmac_f32 v120, v16, v98 row_newbcast:8 row_mask:0xf bank_mask:0xf
    v_permlane32_swap_b32 v17, v5
    v_fmac_f32 v121, v16, v102 row_newbcast:8 row_mask:0xf bank_mask:0xf
    v_add_f32_e64 v17, v17, v5
    v_fmac_f32 v120, v16, v99 row_newbcast:12 row_mask:0xf bank_mask:0xf
    v_mov_b32_e64 v5, v17
    v_fmac_f32 v121, v16, v103 row_newbcast:12 row_mask:0xf bank_mask:0xf
    s_nop 0
    v_permlane16_swap_b32 v17, v5
    v_add_f32 v17, v17, v5
    v_rcp_f32 v17, v17
    v_permlane32_swap_b32 v112, v114
    v_permlane32_swap_b32 v116, v118
    v_mul_f32 v122, v16, v104 row_newbcast:0 row_mask:0xf bank_mask:0xf
    v_permlane32_swap_b32 v113, v115
    v_permlane32_swap_b32 v117, v119
    v_mul_f32 v123, v16, v108 row_newbcast:0 row_mask:0xf bank_mask:0xf
    v_add_f32 v112, v112, v114
    v_add_f32 v116, v116, v118
    v_fmac_f32 v122, v16, v105 row_newbcast:4 row_mask:0xf bank_mask:0xf
    v_add_f32 v113, v113, v115
    v_add_f32 v117, v117, v119
    v_fmac_f32 v123, v16, v109 row_newbcast:4 row_mask:0xf bank_mask:0xf
    v_permlane16_swap_b32 v112, v113
    v_permlane16_swap_b32 v116, v117
    v_fmac_f32 v122, v16, v106 row_newbcast:8 row_mask:0xf bank_mask:0xf
    v_add_f32 v112, v112, v113
    v_add_f32 v116, v116, v117
    v_fmac_f32 v123, v16, v110 row_newbcast:8 row_mask:0xf bank_mask:0xf
    v_fmac_f32 v122, v16, v107 row_newbcast:12 row_mask:0xf bank_mask:0xf
    s_nop 0
    v_fmac_f32 v123, v16, v111 row_newbcast:12 row_mask:0xf bank_mask:0xf
    v_permlane32_swap_b32 v120, v122
    v_mul_f32 v28, v112, v17
    v_permlane32_swap_b32 v121, v123
    v_mul_f32 v29, v116, v17
    v_add_f32 v120, v120, v122
    v_add_f32 v121, v121, v123
    s_nop 1
    v_permlane16_swap_b32 v120, v121
    v_add_f32 v120, v120, v121
    v_mul_f32_e64 v30, v120, v17
    buffer_store_dwordx4 v[28:31], v10, s[16:19], s43 offen
L_T:
    s_mov_b32 exec_lo, 0x0fff0fff
    s_mov_b32 exec_hi, 0x0fff0fff
    s_mov_b32 s28, 0
L_T_x4:
    buffer_load_dwordx4 v[164:167], v160, s[16:19], s87 offen sc1
    s_add_u32 s28, s28, 1
    s_cmp_ge_u32 s28, 24
    s_cbranch_scc1 L_T_x4_long
L_T_x4_chk:
    s_waitcnt vmcnt(0)
    v_cmp_ne_u32 vcc, s26, v167
    s_cbranch_vccnz L_T_x4
L_T_x4_ok:
    s_mov_b64 exec, -1
    v_add_f32 v164, v164, v164 quad_perm:[1,0,3,2] row_mask:0xf bank_mask:0xf
    v_add_f32 v165, v165, v165 quad_perm:[1,0,3,2] row_mask:0xf bank_mask:0xf
    v_add_f32 v166, v166, v166 quad_perm:[1,0,3,2] row_mask:0xf bank_mask:0xf
    v_add_f32 v164, v164, v164 quad_perm:[2,3,0,1] row_mask:0xf bank_mask:0xf
    v_add_f32 v165, v165, v165 quad_perm:[2,3,0,1] row_mask:0xf bank_mask:0xf
    v_add_f32 v166, v166, v166 quad_perm:[2,3,0,1] row_mask:0xf bank_mask:0xf
    v_add_f32 v164, v164, v164 row_half_mirror row_mask:0xf bank_mask:0xf
    v_add_f32 v165, v165, v165 row_half_mirror row_mask:0xf bank_mask:0xf
    v_add_f32 v166, v166, v166 row_half_mirror row_mask:0xf bank_mask:0xf
    v_add_f32 v164, v164, v164 row_mirror row_mask:0xf bank_mask:0xf
    v_add_f32 v165, v165, v165 row_mirror row_mask:0xf bank_mask:0xf
    v_add_f32 v166, v166, v166 row_mirror row_mask:0xf bank_mask:0xf
    v_cvt_pk_bf16_f32 v164, v164, v164
    v_cvt_pk_bf16_f32 v165, v165, v165
    v_cvt_pk_bf16_f32 v166, v166, v166
    v_and_b32 v168, v164, v152
    v_and_b32 v169, v164, v153
    v_and_b32_e64 v170, v164, v154
    v_and_b32 v171, v164, v155
    s_nop 1
    v_mfma_f32_16x16x32_bf16 v[184:187], v[168:171], a[192:195], 0
    v_and_b32 v172, v165, v152
    v_and_b32 v173, v165, v153
    v_mfma_f32_16x16x32_bf16 v[188:191], v[168:171], a[196:199], 0
    v_and_b32 v174, v165, v154
    v_and_b32 v175, v165, v155
    v_mfma_f32_16x16x32_bf16 v[192:195], v[168:171], a[200:203], 0
    v_and_b32 v176, v166, v152
    v_and_b32 v177, v166, v153
    v_mfma_f32_16x16x32_bf16 v[184:187], v[172:175], a[212:215], v[184:187]
    v_and_b32 v178, v166, v154
    v_and_b32 v179, v166, v155
    v_mfma_f32_16x16x32_bf16 v[188:191], v[172:175], a[216:219], v[188:191]
    buffer_atomic_add v161, v162, s[16:19], s83 offen sc1
    v_mfma_f32_16x16x32_bf16 v[184:187], v[176:179], a[232:235], v[184:187]
    s_nop 1
    v_mfma_f32_16x16x32_bf16 v[188:191], v[176:179], a[236:239], v[188:191]
    s_nop 1
    v_mfma_f32_16x16x32_bf16 v[192:195], v[172:175], a[220:223], v[192:195]
    s_nop 1
    v_mfma_f32_16x16x32_bf16 v[192:195], v[176:179], a[240:243], v[192:195]
    ds_write_b128 v156, v[184:187] offset:0
    s_nop 0
    v_mfma_f32_16x16x32_bf16 v[196:199], v[168:171], a[204:207], 0
    ds_write_b128 v156, v[188:191] offset:512
    s_nop 0
    v_mfma_f32_16x16x32_bf16 v[196:199], v[172:175], a[224:227], v[196:199]
    s_nop 1
    v_mfma_f32_16x16x32_bf16 v[196:199], v[176:179], a[244:247], v[196:199]
    ds_write_b128 v156, v[192:195] offset:1024
    s_nop 0
    v_mfma_f32_16x16x32_bf16 v[200:203], v[168:171], a[208:211], 0
    s_nop 1
    v_mfma_f32_16x16x32_bf16 v[200:203], v[172:175], a[228:231], v[200:203]
    s_nop 1
    v_mfma_f32_16x16x32_bf16 v[200:203], v[176:179], a[248:251], v[200:203]
    ds_write_b128 v156, v[196:199] offset:1536
    s_nop 6
    ds_write_b128 v156, v[200:203] offset:2048
    s_mov_b32 exec_hi, 0xff
    s_waitcnt lgkmcnt(0)
    s_barrier
    ds_read_b128 v[168:171], v157 offset:0
    ds_read_b128 v[172:175], v157 offset:2560
    ds_read_b128 v[176:179], v157 offset:5120
    ds_read_b128 v[180:183], v157 offset:7680
    s_waitcnt lgkmcnt(2)
    v_pk_add_f32 v[168:169], v[168:169], v[172:173]
    v_pk_add_f32 v[170:171], v[170:171], v[174:175]
    s_waitcnt lgkmcnt(0)
    v_pk_add_f32 v[176:177], v[176:177], v[180:181]
    v_pk_add_f32 v[178:179], v[178:179], v[182:183]
    v_pk_add_f32 v[170:171], v[170:171], v[178:179]
    v_pk_add_f32 v[168:169], v[168:169], v[176:177]
    v_min_u32 v171, -2, v171
    buffer_store_dwordx4 v[168:171], v158, s[16:19], s88 offen sc1
    s_mov_b64 exec, -1
    s_cmp_eq_u32 s80, 31
    s_cbranch_scc1 L_T_end
    buffer_store_dwordx4 v[28:31], v163, s[16:19], s43 offen sc1
L_T_end:
L_exit:
    s_endpgm
.p2align 8
L_A:
    v_lshrrev_b32_e64 v2, 6, v0
    v_and_b32 v1, 63, v0
    v_readfirstlane_b32 s3, v2
    s_and_b32 s24, s2, 3
    s_bfe_u32 s27, s2, 0x10002
    s_lshl1_add_u32 s24, s24, s27
    s_mov_b32 s18, 268435456
    s_mov_b32 s19, 0x20000
    s_mov_b32 s6, 1280
    s_mov_b32 s7, 0x20000
    s_mov_b32 s10, 7864320
    s_mov_b32 s11, 0x20000
    v_lshrrev_b32 v2, 3, v1
    v_and_b32 v5, 7, v1
    v_mul_u32_u24 v6, 12288, v2
    v_lshl_add_u32 v6, v5, 4, v6
    s_and_b32 s46, s25, 3
    s_lshl2_add_u32 s46, s46, s3
    s_lshr_b32 s27, s25, 2
    s_lshl2_add_u32 s27, s24, s27
    s_mul_i32 s44, s46, 491520
    s_mul_i32 s35, s46, 80
    v_lshlrev_b32_e64 v7, 1, v2
    s_mul_i32 s27, s27, 384
    s_add_u32 s44, s44, s27
    s_mov_b32 s45, 98304
    s_waitcnt lgkmcnt(0)
    buffer_load_dwordx4 a[0:3], v6, s[8:11], s44 offen offset:0 nt
    buffer_load_dwordx4 a[4:7], v6, s[8:11], s44 offen offset:128 nt
    buffer_load_dwordx4 a[8:11], v6, s[8:11], s44 offen offset:256 nt
    s_add_u32 s44, s44, s45
    buffer_load_dwordx4 a[12:15], v6, s[8:11], s44 offen offset:0 nt
    buffer_load_dwordx4 a[16:19], v6, s[8:11], s44 offen offset:128 nt
    buffer_load_dwordx4 a[20:23], v6, s[8:11], s44 offen offset:256 nt
    s_add_u32 s44, s44, s45
    buffer_load_dwordx4 a[24:27], v6, s[8:11], s44 offen offset:0 nt
    buffer_load_dwordx4 a[28:31], v6, s[8:11], s44 offen offset:128 nt
    v_lshlrev_b32 v3, 4, v1
    v_lshlrev_b32 v4, 2, v1
    buffer_load_dwordx4 v[8:11], v3, s[4:7], 0 offen
    buffer_load_dword v12, v4, s[4:7], 0 offen offset:1024
    buffer_load_ushort v13, v7, s[4:7], s35 offen offset:0
    buffer_load_ushort v14, v7, s[4:7], s35 offen offset:16
    buffer_load_ushort v15, v7, s[4:7], s35 offen offset:32
    buffer_load_ushort v16, v7, s[4:7], s35 offen offset:48
    buffer_load_ushort v17, v7, s[4:7], s35 offen offset:64
    buffer_load_dwordx4 a[32:35], v6, s[8:11], s44 offen offset:256 nt
    s_add_u32 s44, s44, s45
    s_load_dword s26, s[16:17], 0
    s_load_dwordx2 s[30:31], s[0:1], 96
    s_load_dwordx2 s[12:13], s[0:1], 8
    s_load_dwordx2 s[84:85], s[0:1], 88
    s_lshl_b32 s89, s24, 4
    s_add_u32 s89, s89, s25
    s_lshl_b32 s88, s89, 10
    s_add_u32 s88, s88, 2686976
    v_and_b32 v3, 1, v1
    v_lshlrev_b32 v3, 4, v3
    v_mov_b32 v4, 0xffff
    v_lshlrev_b32_e64 v3, v3, v4
    v_bfe_u32 v4, v1, 1, 2
    v_cmp_eq_u32 vcc, 0, v4
    s_nop 1
    v_cndmask_b32 v152, 0, v3, vcc
    v_cmp_eq_u32 vcc, 1, v4
    s_nop 1
    v_cndmask_b32 v153, 0, v3, vcc
    v_cmp_eq_u32 vcc, 2, v4
    s_nop 1
    v_cndmask_b32 v154, 0, v3, vcc
    v_cmp_eq_u32 vcc, 3, v4
    s_nop 1
    v_cndmask_b32 v155, 0, v3, vcc
    v_lshlrev_b32 v149, 4, v1
    s_cmp_eq_u32 s3, 0
    s_cselect_b32 s27, 64, 0
    v_cmp_gt_u32 vcc, s27, v1
    v_mov_b32 v148, 0x20000000
    s_nop 0
    v_cndmask_b32 v148, v148, v149, vcc
    v_lshrrev_b32 v3, 1, v2
    v_xor_b32 v3, v3, v5
    v_mul_u32_u24 v4, 1536, v2
    v_lshl_add_u32 v62, v3, 4, v4
    v_xor_b32_e64 v63, 64, v62
    v_add_u32 v63, 12288, v63
    s_mul_i32 s35, s89, 98304
    s_mul_i32 s28, s3, 384
    s_add_u32 s35, s35, s28
    s_xor_b32 s28, s3, 0
    s_mul_i32 s28, s28, 24576
    s_add_u32 s96, s35, s28
    s_xor_b32 s28, s3, 1
    s_mul_i32 s28, s28, 24576
    s_add_u32 s97, s35, s28
    s_xor_b32 s28, s3, 2
    s_mul_i32 s28, s28, 24576
    s_add_u32 s98, s35, s28
    s_xor_b32 s28, s3, 3
    s_mul_i32 s28, s28, 24576
    s_add_u32 s99, s35, s28
    s_mul_i32 s37, s3, 24608
    s_mov_b32 m0, s37
    s_movk_i32 s100, 896
    s_movk_i32 s101, 1280
    s_waitcnt vmcnt(1) lgkmcnt(0)
    s_mul_i32 s26, s26, 0x9e3779b1
    s_add_u32 s26, s26, 0x7f4a7c15
    s_mov_b32 s14, 12582912
    s_mov_b32 s15, 0x20000
    buffer_load_dwordx4 a[36:39], v6, s[8:11], s44 offen offset:0 nt
    buffer_load_dwordx4 a[40:43], v6, s[8:11], s44 offen offset:128 nt
    buffer_load_dwordx4 a[44:47], v6, s[8:11], s44 offen offset:256 nt
    s_add_u32 s44, s44, s45
    buffer_load_dwordx4 a[48:51], v6, s[8:11], s44 offen offset:0 nt
    buffer_load_dwordx4 a[52:55], v6, s[8:11], s44 offen offset:128 nt
    buffer_load_dwordx4 a[56:59], v6, s[8:11], s44 offen offset:256 nt
    v_lshlrev_b32_e64 v24, 16, v8
    v_and_b32 v25, 0xffff0000, v8
    v_lshlrev_b32_e64 v26, 16, v9
    v_and_b32 v27, 0xffff0000, v9
    v_lshlrev_b32_e64 v28, 16, v10
    v_and_b32 v29, 0xffff0000, v10
    v_lshlrev_b32_e64 v30, 16, v11
    v_and_b32 v31, 0xffff0000, v11
    v_lshlrev_b32_e64 v32, 16, v12
    v_and_b32 v33, 0xffff0000, v12
    v_add_f32 v34, v24, v25
    v_add_f32 v34, v34, v26
    v_add_f32 v34, v34, v27
    v_add_f32 v34, v34, v28
    v_add_f32 v34, v34, v29
    v_add_f32 v34, v34, v30
    v_add_f32 v34, v34, v31
    v_add_f32 v34, v34, v32
    v_add_f32 v34, v34, v33
    s_nop 1
    v_add_f32 v34, v34, v34 quad_perm:[1,0,3,2] row_mask:0xf bank_mask:0xf
    s_nop 1
    v_add_f32 v34, v34, v34 quad_perm:[2,3,0,1] row_mask:0xf bank_mask:0xf
    s_nop 1
    v_add_f32 v34, v34, v34 row_half_mirror row_mask:0xf bank_mask:0xf
    s_nop 1
    v_add_f32 v34, v34, v34 row_mirror row_mask:0xf bank_mask:0xf
    s_nop 1
    v_add_f32 v34, v34, v34 row_bcast:15 row_mask:0xa bank_mask:0xf
    s_nop 1
    v_add_f32 v34, v34, v34 row_bcast:31 row_mask:0xc bank_mask:0xf
    s_nop 0
    v_readlane_b32 s32, v34, 63
    v_mov_b32 v34, 0x3acccccd
    s_nop 0
    v_mul_f32 v34, s32, v34
    v_sub_f32 v24, v24, v34
    v_sub_f32 v25, v25, v34
    v_sub_f32 v26, v26, v34
    v_sub_f32 v27, v27, v34
    v_sub_f32 v28, v28, v34
    v_sub_f32 v29, v29, v34
    v_sub_f32 v30, v30, v34
    v_sub_f32 v31, v31, v34
    v_sub_f32 v32, v32, v34
    v_sub_f32 v33, v33, v34
    v_mul_f32 v35, v24, v24
    v_fmac_f32 v35, v25, v25
    v_fmac_f32 v35, v26, v26
    v_fmac_f32 v35, v27, v27
    v_fmac_f32 v35, v28, v28
    v_fmac_f32 v35, v29, v29
    v_fmac_f32 v35, v30, v30
    v_fmac_f32 v35, v31, v31
    v_fmac_f32_e64 v35, v32, v32
    v_fmac_f32 v35, v33, v33
    s_nop 1
    v_add_f32 v35, v35, v35 quad_perm:[1,0,3,2] row_mask:0xf bank_mask:0xf
    s_nop 1
    v_add_f32 v35, v35, v35 quad_perm:[2,3,0,1] row_mask:0xf bank_mask:0xf
    s_nop 1
    v_add_f32 v35, v35, v35 row_half_mirror row_mask:0xf bank_mask:0xf
    s_nop 1
    v_add_f32 v35, v35, v35 row_mirror row_mask:0xf bank_mask:0xf
    s_nop 1
    v_add_f32 v35, v35, v35 row_bcast:15 row_mask:0xa bank_mask:0xf
    s_nop 1
    v_add_f32 v35, v35, v35 row_bcast:31 row_mask:0xc bank_mask:0xf
    s_nop 0
    v_readlane_b32 s33, v35, 63
    v_mov_b32 v35, 0x3acccccd
    s_nop 0
    v_mul_f32 v35, s33, v35
    v_cvt_pk_bf16_f32 v34, v34, v34
    v_and_b32 v34, 0xffff0000, v34
    v_cvt_pk_bf16_f32 v35, v35, v35
    v_and_b32 v35, 0xffff0000, v35
    v_add_f32 v35, 0x3727c5ac, v35
    v_cvt_pk_bf16_f32 v35, v35, v35
    v_and_b32 v35, 0xffff0000, v35
    v_sqrt_f32 v35, v35
    v_readfirstlane_b32 s32, v34
    v_cvt_pk_bf16_f32 v35, v35, v35
    v_and_b32 v35, 0xffff0000, v35
    v_rcp_f32 v34, v35
    v_readfirstlane_b32 s33, v35
    v_readfirstlane_b32 s34, v34
    v_lshlrev_b32 v13, 16, v13
    v_subrev_f32_e64 v13, s32, v13
    v_cvt_pk_bf16_f32 v13, v13, v13
    v_and_b32 v13, 0xffff0000, v13
    v_mul_f32_e64 v3, s34, v13
    v_fma_f32 v13, -v3, s33, v13
    v_fmac_f32_e64 v3, s34, v13
    v_cvt_pk_bf16_f32 v13, v3, v3
    v_and_b32 v24, v13, v152
    v_and_b32 v25, v13, v153
    v_and_b32 v26, v13, v154
    v_and_b32 v27, v13, v155
    v_lshlrev_b32 v14, 16, v14
    v_subrev_f32 v14, s32, v14
    v_cvt_pk_bf16_f32 v14, v14, v14
    v_and_b32 v14, 0xffff0000, v14
    v_mul_f32_e64 v3, s34, v14
    v_fma_f32 v14, -v3, s33, v14
    v_fmac_f32_e64 v3, s34, v14
    v_cvt_pk_bf16_f32 v14, v3, v3
    v_and_b32 v28, v14, v152
    v_and_b32 v29, v14, v153
    v_and_b32 v30, v14, v154
    v_and_b32 v31, v14, v155
    v_lshlrev_b32 v15, 16, v15
    v_subrev_f32 v15, s32, v15
    v_cvt_pk_bf16_f32 v15, v15, v15
    v_and_b32 v15, 0xffff0000, v15
    v_mul_f32_e64 v3, s34, v15
    v_fma_f32 v15, -v3, s33, v15
    v_fmac_f32_e64 v3, s34, v15
    v_cvt_pk_bf16_f32 v15, v3, v3
    v_and_b32 v32, v15, v152
    v_and_b32 v33, v15, v153
    v_and_b32 v34, v15, v154
    v_and_b32 v35, v15, v155
    v_lshlrev_b32 v16, 16, v16
    v_subrev_f32 v16, s32, v16
    v_cvt_pk_bf16_f32 v16, v16, v16
    v_and_b32 v16, 0xffff0000, v16
    v_mul_f32_e64 v3, s34, v16
    v_fma_f32 v16, -v3, s33, v16
    v_fmac_f32_e64 v3, s34, v16
    v_cvt_pk_bf16_f32 v16, v3, v3
    v_and_b32 v36, v16, v152
    v_and_b32 v37, v16, v153
    v_and_b32 v38, v16, v154
    v_and_b32 v39, v16, v155
    v_lshlrev_b32 v17, 16, v17
    v_subrev_f32 v17, s32, v17
    v_cvt_pk_bf16_f32 v17, v17, v17
    v_and_b32 v17, 0xffff0000, v17
    v_mul_f32_e64 v3, s34, v17
    v_fma_f32 v17, -v3, s33, v17
    v_fmac_f32_e64 v3, s34, v17
    v_cvt_pk_bf16_f32 v17, v3, v3
    v_and_b32 v40, v17, v152
    v_and_b32 v41, v17, v153
    v_and_b32 v42, v17, v154
    v_and_b32 v43, v17, v155
    v_bfe_u32 v3, v1, 3, 1
    v_mul_u32_u24 v3, 768, v3
    v_lshl_add_u32 v3, v5, 5, v3
    v_and_b32_e64 v4, 16, v1
    s_mul_i32 s28, s3, 1536
    s_add_u32 s28, s28, 98432
    v_add3_u32 v22, v3, v4, s28
    v_lshlrev_b32_e64 v23, 2, v1
    v_add_u32 v23, 98432, v23
    v_lshlrev_b32 v10, 4, v1
    s_load_dwordx2 s[8:9], s[0:1], 80
    v_mfma_f32_16x16x32_bf16 v[44:47], v[24:27], a[0:3], 0
    v_mfma_f32_16x16x32_bf16 v[48:51], v[24:27], a[4:7], 0
    v_mfma_f32_16x16x32_bf16 v[52:55], v[24:27], a[8:11], 0
    v_mfma_f32_16x16x32_bf16 v[44:47], v[28:31], a[12:15], v[44:47]
    v_mfma_f32_16x16x32_bf16 v[48:51], v[28:31], a[16:19], v[48:51]
    v_mfma_f32_16x16x32_bf16 v[52:55], v[28:31], a[20:23], v[52:55]
    buffer_load_dwordx4 v62, s[12:15], s96 offen offset:0  lds
    s_add_u32 m0, m0, s100
    s_nop 0
    buffer_load_dwordx4 v62, s[12:15], s96 offen offset:128  lds
    s_add_u32 m0, m0, s100
    s_waitcnt vmcnt(8)
    buffer_load_dwordx4 v62, s[12:15], s96 offen offset:256  lds
    s_add_u32 m0, m0, s101
    v_mfma_f32_16x16x32_bf16 v[44:47], v[32:35], a[24:27], v[44:47]
    v_mfma_f32_16x16x32_bf16 v[48:51], v[32:35], a[28:31], v[48:51]
    v_mfma_f32_16x16x32_bf16 v[52:55], v[32:35], a[32:35], v[52:55]
    s_waitcnt vmcnt(6)
    v_mfma_f32_16x16x32_bf16 v[44:47], v[36:39], a[36:39], v[44:47]
    v_mfma_f32_16x16x32_bf16 v[48:51], v[36:39], a[40:43], v[48:51]
    v_mfma_f32_16x16x32_bf16 v[52:55], v[36:39], a[44:47], v[52:55]
    s_waitcnt vmcnt(3)
    v_mfma_f32_16x16x32_bf16 v[44:47], v[40:43], a[48:51], v[44:47]
    v_mfma_f32_16x16x32_bf16 v[48:51], v[40:43], a[52:55], v[48:51]
    v_mfma_f32_16x16x32_bf16 v[52:55], v[40:43], a[56:59], v[52:55]
    s_mov_b32 exec_lo, 0x00ff00ff
    s_mov_b32 exec_hi, 0xff00ff00
    s_nop 3
    ds_write_b128 v22, v[44:47] offset:0
    ds_write_b128 v22, v[48:51] offset:256
    ds_write_b128 v22, v[52:55] offset:512
    s_mov_b64 exec, -1
    s_waitcnt lgkmcnt(0)
    s_barrier
    s_cmp_lg_u32 s3, 0
    s_cbranch_scc1 L_A_q_nopub
    ds_read2st64_b32 v[64:65], v23 offset0:0 offset1:1
    ds_read2st64_b32 v[66:67], v23 offset0:2 offset1:3
    ds_read2st64_b32 v[68:69], v23 offset0:4 offset1:5
    ds_read2st64_b32 v[70:71], v23 offset0:6 offset1:7
    ds_read2st64_b32 v[72:73], v23 offset0:8 offset1:9
    ds_read2st64_b32 v[74:75], v23 offset0:10 offset1:11
    ds_read2st64_b32 v[76:77], v23 offset0:12 offset1:13
    ds_read2st64_b32 v[78:79], v23 offset0:14 offset1:15
    ds_read2st64_b32 v[80:81], v23 offset0:16 offset1:17
    ds_read2st64_b32 v[82:83], v23 offset0:18 offset1:19
    ds_read2st64_b32 v[84:85], v23 offset0:20 offset1:21
    ds_read2st64_b32 v[86:87], v23 offset0:22 offset1:23
    v_mov_b32 v235, s26
    s_waitcnt lgkmcnt(6)
    v_add_f32 v232, v64, v67
    v_add_f32 v233, v65, v68
    v_add_f32 v234, v66, v69
    v_add_f32 v232, v232, v70
    v_add_f32 v233, v233, v71
    v_add_f32 v234, v234, v72
    v_add_f32 v232, v232, v73
    v_add_f32 v233, v233, v74
    v_add_f32 v234, v234, v75
    s_waitcnt lgkmcnt(0)
    v_add_f32 v232, v232, v76
    v_add_f32 v233, v233, v77
    v_add_f32 v234, v234, v78
    v_add_f32 v232, v232, v79
    v_add_f32 v233, v233, v80
    v_add_f32 v234, v234, v81
    v_add_f32 v232, v232, v82
    v_add_f32 v233, v233, v83
    v_add_f32 v234, v234, v84
    v_add_f32 v232, v232, v85
    v_add_f32_e64 v233, v233, v86
    v_add_f32 v234, v234, v87
    buffer_store_dwordx4 v[232:235], v10, s[16:19], s88 offen
L_A_q_nopub:
    s_barrier
    buffer_load_dwordx4 v63, s[12:15], s96 offen offset:0  lds
    s_add_u32 m0, m0, s100
    s_nop 0
    buffer_load_dwordx4 v63, s[12:15], s96 offen offset:128  lds
    s_add_u32 m0, m0, s100
    s_nop 0
    buffer_load_dwordx4 v63, s[12:15], s96 offen offset:256  lds
    s_add_u32 m0, m0, s101
    s_nop 0
    buffer_load_dwordx4 v62, s[12:15], s97 offen offset:0  lds
    s_add_u32 m0, m0, s100
    s_nop 0
    buffer_load_dwordx4 v62, s[12:15], s97 offen offset:128  lds
    s_add_u32 m0, m0, s100
    s_waitcnt vmcnt(7)
    buffer_load_dwordx4 v62, s[12:15], s97 offen offset:256  lds
    s_add_u32 m0, m0, s101
    s_waitcnt vmcnt(7)
    buffer_load_dwordx4 v63, s[12:15], s97 offen offset:0  lds
    s_add_u32 m0, m0, s100
    s_waitcnt vmcnt(7)
    buffer_load_dwordx4 v63, s[12:15], s97 offen offset:128  lds
    s_add_u32 m0, m0, s100
    s_lshl_b32 s27, s25, 2
    s_add_u32 s27, s27, s3
    s_lshl_b32 s42, s27, 10
    s_mul_i32 s28, s24, 73728
    s_add_u32 s42, s42, s28
    s_add_u32 s42, s42, 262144
    s_lshl_b32 s43, s25, 9
    s_add_u32 s43, s43, s28
    s_lshl_b32 s27, s3, 2
    s_add_u32 s43, s43, s27
    s_add_u32 s43, s43, 327680
    v_lshrrev_b32 v3, 5, v1
    v_lshl_or_b32 v32, v3, 29, v10
    v_and_b32 v2, 31, v1
    v_lshrrev_b32 v3, 5, v1
    v_lshrrev_b32_e64 v4, 3, v2
    v_mul_u32_u24 v4, 3072, v4
    v_lshl_add_u32 v4, v5, 7, v4
    v_bfe_u32 v11, v2, 1, 3
    v_xor_b32 v11, v11, v3
    s_and_b32 s28, s25, 3
    s_lshl_b32 s27, s28, 1
    v_xor_b32 v11, s27, v11
    v_lshl_add_u32 v4, v11, 4, v4
    v_add_u32_e64 v20, s37, v4
    s_waitcnt vmcnt(7)
    buffer_load_dwordx4 v63, s[12:15], s97 offen offset:256  lds
    s_add_u32 m0, m0, s101
    v_xad_u32 v21, v4, 32, s37
    v_xad_u32 v22, v4, 64, s37
    v_xor_b32_e64 v4, 64, v4
    v_xad_u32 v23, v4, 32, s37
    v_lshrrev_b32 v4, 2, v2
    v_lshlrev_b32 v4, 7, v4
    v_lshl_add_u32 v4, v3, 6, v4
    v_and_b32_e64 v11, 3, v1
    v_lshl_add_u32 v24, v11, 4, v4
    s_xor_b32 s27, s28, 0
    v_lshl_add_u32 v224, s27, 10, v24
    s_xor_b32 s27, s28, 1
    s_waitcnt vmcnt(7)
    buffer_load_dwordx4 v62, s[12:15], s98 offen offset:0  lds
    s_add_u32 m0, m0, s100
    v_lshl_add_u32 v225, s27, 10, v24
    s_xor_b32 s27, s28, 2
    v_lshl_add_u32 v226, s27, 10, v24
    s_xor_b32 s27, s28, 3
    v_lshl_add_u32 v227, s27, 10, v24
    s_mul_i32 s38, s3, 12288
    s_add_u32 s38, s38, 1245184
    s_add_u32 s39, s38, 4096
    s_add_u32 s40, s38, 8192
    s_mov_b32 s27, 0x15555556
    v_add_u32_e64 v4, 0, v1
    v_mul_hi_u32 v11, v4, s27
    s_waitcnt vmcnt(7)
    buffer_load_dwordx4 v62, s[12:15], s98 offen offset:128  lds
    s_add_u32 m0, m0, s100
    v_mul_u32_u24 v11, 1344, v11
    v_lshl_add_u32 v25, v4, 4, v11
    v_add_u32_e64 v4, 64, v1
    v_mul_hi_u32 v11, v4, s27
    v_mul_u32_u24 v11, 1344, v11
    v_lshl_add_u32 v26, v4, 4, v11
    v_add_u32 v4, 128, v1
    v_mul_hi_u32 v11, v4, s27
    v_mul_u32_u24 v11, 1344, v11
    v_lshl_add_u32 v27, v4, 4, v11
    s_lshr_b32 s27, s25, 3
    s_lshl_b32 s35, s24, 1
    s_waitcnt vmcnt(7)
    buffer_load_dwordx4 v62, s[12:15], s98 offen offset:256  lds
    s_add_u32 m0, m0, s101
    s_add_u32 s35, s35, s27
    s_and_b32 s36, s25, 7
    s_lshl_b32 s27, s35, 2
    s_add_u32 s27, s27, s3
    s_mul_i32 s41, s27, 196608
    s_mul_i32 s27, s36, 192
    s_add_u32 s41, s41, s27
    s_movk_i32 s46, 1024
    s_movk_i32 s47, 24576
    s_xor_b32 s27, s3, 1
    s_mul_i32 s27, s27, 6144
    s_add_u32 s27, s27, 98432
    s_waitcnt vmcnt(7)
    buffer_load_dwordx4 v63, s[12:15], s98 offen offset:0  lds
    s_add_u32 m0, m0, s100
    v_add_u32 v28, s27, v10
    s_xor_b32 s27, s3, 2
    s_mul_i32 s27, s27, 6144
    s_add_u32 s27, s27, 100480
    v_add_u32 v29, s27, v10
    s_xor_b32 s27, s3, 3
    s_mul_i32 s27, s27, 6144
    s_add_u32 s27, s27, 102528
    v_add_u32_e64 v30, s27, v10
    s_mul_i32 s27, s3, 6144
    s_add_u32 s27, s27, 98432
    v_add_u32 v31, s27, v10
    s_waitcnt vmcnt(7)
    buffer_load_dwordx4 v63, s[12:15], s98 offen offset:128  lds
    s_add_u32 m0, m0, s100
    v_and_b32 v18, 15, v1
    v_lshrrev_b32 v19, 4, v1
    v_lshlrev_b32 v4, 13, v19
    v_lshl_add_u32 v33, v18, 4, v4
    v_lshlrev_b32_e64 v4, 10, v19
    v_lshl_add_u32 v34, v18, 4, v4
    s_lshr_b32 s27, s3, 1
    s_and_b32 s28, s3, 1
    s_lshl_b32 s44, s35, 15
    s_lshl_b32 s20, s24, 13
    s_add_u32 s44, s44, s20
    s_lshl_b32 s20, s27, 8
    s_waitcnt vmcnt(7)
    buffer_load_dwordx4 v63, s[12:15], s98 offen offset:256  lds
    s_add_u32 m0, m0, s101
    s_load_dword s92, s[30:31], 128
    s_add_u32 s44, s44, s20
    s_add_u32 s44, s44, 262144
    s_add_u32 s45, s44, 4096
    s_lshl_b32 s20, s35, 12
    s_lshl_b32 s21, s24, 16
    s_add_u32 s20, s20, s21
    s_lshl_b32 s21, s27, 8
    s_add_u32 s20, s20, s21
    s_add_u32 s20, s20, 327680
    v_mul_u32_u24 v4, 24608, v19
    v_lshrrev_b32 v11, 2, v18
    v_mul_u32_u24 v11, 192, v11
    s_waitcnt vmcnt(7)
    buffer_load_dwordx4 v62, s[12:15], s99 offen offset:0  lds
    s_add_u32 m0, m0, s100
    v_add_u32 v4, v4, v11
    v_and_b32_e64 v11, 3, v1
    v_lshl_add_u32 v4, v11, 3, v4
    s_mul_i32 s21, s28, 96
    v_add_u32_e64 v35, s21, v4
    v_lshl_add_u32 v36, v18, 2, v19
    v_lshlrev_b32 v36, 2, v36
    v_lshrrev_b32 v4, 2, v1
    v_mul_u32_u24 v4, 24576, v4
    v_lshl_add_u32 v37, v11, 4, v4
    v_lshl_add_u32 v38, v11, 3, v4
    s_mul_i32 s21, s27, 393216
    s_waitcnt vmcnt(7)
    buffer_load_dwordx4 v62, s[12:15], s99 offen offset:128  lds
    s_add_u32 m0, m0, s100
    s_mul_i32 s22, s35, 1536
    s_add_u32 s21, s21, s22
    s_add_u32 s21, s21, 1441792
    s_lshl_b32 s23, s36, 1
    s_add_u32 s23, s23, s28
    s_lshl_b32 s22, s23, 5
    s_add_u32 s22, s22, s21
    s_add_u32 s22, s22, 1024
    s_lshl_b32 s28, s23, 6
    s_add_u32 s21, s21, s28
    s_lshl_b32 s35, s35, 8
    s_lshl_b32 s27, s27, 7
    s_waitcnt vmcnt(7)
    buffer_load_dwordx4 v62, s[12:15], s99 offen offset:256  lds
    s_add_u32 m0, m0, s101
    s_add_u32 s35, s35, s27
    s_lshl_b32 s27, s36, 12
    s_add_u32 s35, s35, s27
    s_add_u32 s35, s35, 1409024
    v_mov_b32 v40, 0x3f803f80
    v_mov_b32 v41, 0x3f803f80
    v_mov_b32 v42, 0x3f803f80
    v_mov_b32 v43, 0x3f803f80
    s_lshl_b32 s81, s36, 7
    s_add_u32 s81, s81, 1343488
    v_mov_b32 v161, 1
    v_lshlrev_b32 v4, 10, v1
    s_waitcnt vmcnt(7)
    buffer_load_dwordx4 v63, s[12:15], s99 offen offset:0  lds
    s_add_u32 m0, m0, s100
    s_waitcnt lgkmcnt(0)
    s_cmp_lt_u32 s92, 32
    s_cbranch_scc1 L_A_fslow
L_A_fok:
    s_getreg_b32 s80, hwreg(HW_REG_XCC_ID, 0, 4)
    s_lshl_b32 s80, s80, 2
    s_lshl_b32 s93, s24, 7
    s_add_u32 s80, s80, s93
    s_add_u32 s80, s80, 1310720
    s_cmp_lg_u32 s3, 0
    s_cbranch_scc1 L_A_nocensus
    s_mov_b32 s93, 1
    s_atomic_add s93, s[16:17], s80
L_A_nocensus:
    s_cmp_eq_u32 s3, 0
    s_cselect_b32 s27, 8, 0
    v_cmp_gt_u32 vcc, s27, v1
    v_mov_b32 v162, 0x20000000
    s_nop 0
    v_cndmask_b32 v162, v162, v4, vcc
    s_and_b32 s23, s3, 1
    v_lshlrev_b32 v4, 3, v1
    s_cmp_eq_u32 s23, 0
    s_cselect_b32 s27, 16, 0
    v_cmp_gt_u32 vcc, s27, v1
    v_mov_b32 v39, 0x20000000
    s_nop 0
    v_cndmask_b32 v39, v39, v4, vcc
    s_waitcnt vmcnt(7)
    buffer_load_dwordx4 v63, s[12:15], s99 offen offset:128  lds
    s_add_u32 m0, m0, s100
    s_lshr_b32 s27, s89, 2
    s_lshl_b32 s27, s27, 9
    s_add_u32 s27, s27, 1294336
    s_add_u32 s90, s16, s27
    s_addc_u32 s91, s17, 0
    s_mov_b32 s10, 1280
    s_mov_b32 s11, 0x20000
    s_mov_b32 s86, 1280
    s_mov_b32 s87, 0x20000
    s_cmp_lg_u32 s3, 0
    s_cbranch_scc1 L_A_nolook
    s_load_dword s92, s[90:91], 0 glc
    s_load_dword s94, s[90:91], 128 glc
    s_load_dword s95, s[90:91], 256 glc
    s_load_dword s83, s[90:91], 384 glc
L_A_nolook:
    s_waitcnt vmcnt(7)
    buffer_load_dwordx4 v63, s[12:15], s99 offen offset:256  lds
    s_add_u32 m0, m0, s101
    s_waitcnt lgkmcnt(0)
    ds_read_b128 a[160:163], v20 offset:0
    ds_read_b128 a[164:167], v21 offset:0
    ds_read_b128 a[168:171], v22 offset:0
    ds_read_b128 a[172:175], v23 offset:0
    ds_read_b128 a[176:179], v20 offset:1024
    ds_read_b128 a[180:183], v21 offset:1024
    ds_read_b128 a[184:187], v22 offset:1024
    ds_read_b128 a[188:191], v23 offset:1024
    ds_read_b128 a[192:195], v20 offset:2048
    ds_read_b128 a[196:199], v21 offset:2048
    ds_read_b128 a[200:203], v22 offset:2048
    ds_read_b128 a[204:207], v23 offset:2048
    s_mov_b32 m0, s37
    s_cmp_lg_u32 s3, 0
    s_cbranch_scc1 L_A_n2_out
    s_min_i32 s92, s92, s94
    s_min_i32 s95, s95, s83
    s_min_i32 s92, s92, s95
    s_cmp_ge_i32 s92, 23
    s_cbranch_scc1 L_A_n2_out
    s_mov_b32 s28, 0
L_A_n2:
    s_cmp_eq_u32 s28, 16
    s_cbranch_scc1 L_A_n2_late
L_A_n2_go:
    s_load_dword s92, s[90:91], 0 glc
    s_load_dword s93, s[90:91], 128 glc
    s_load_dword s94, s[90:91], 256 glc
    s_load_dword s95, s[90:91], 384 glc
    s_add_u32 s28, s28, 1
    s_cmp_ge_u32 s28, 200000
    s_waitcnt lgkmcnt(0)
    s_cbranch_scc1 L_A_n2_out
    s_min_i32 s27, s92, s93
    s_min_i32 s27, s27, s94
    s_min_i32 s27, s27, s95
    s_cmp_lt_i32 s27, 23
    s_cbranch_scc1 L_A_n2
L_A_n2_out:
    s_barrier
    buffer_load_dwordx4 v[64:67], v224, s[16:19], s38 offen sc1
    buffer_load_dwordx4 v[68:71], v225, s[16:19], s38 offen sc1
    s_barrier
    buffer_load_dwordx4 v[72:75], v226, s[16:19], s38 offen sc1
    buffer_load_dwordx4 v[76:79], v227, s[16:19], s38 offen sc1
    s_barrier
    buffer_load_dwordx4 v[80:83], v224, s[16:19], s39 offen sc1
    buffer_load_dwordx4 v[84:87], v225, s[16:19], s39 offen sc1
    s_barrier
    buffer_load_dwordx4 v[88:91], v226, s[16:19], s39 offen sc1
    buffer_load_dwordx4 v[92:95], v227, s[16:19], s39 offen sc1
    s_barrier
    buffer_load_dwordx4 v[96:99], v224, s[16:19], s40 offen sc1
    buffer_load_dwordx4 v[100:103], v225, s[16:19], s40 offen sc1
    s_barrier
    buffer_load_dwordx4 v[104:107], v226, s[16:19], s40 offen sc1
    buffer_load_dwordx4 v[108:111], v227, s[16:19], s40 offen sc1
    s_waitcnt vmcnt(12)
    ds_read_b128 a[208:211], v20 offset:12288
    ds_read_b128 a[212:215], v21 offset:12288
    ds_read_b128 a[216:219], v22 offset:12288
    ds_read_b128 a[220:223], v23 offset:12288
    ds_read_b128 a[224:227], v20 offset:13312
    ds_read_b128 a[228:231], v21 offset:13312
    ds_read_b128 a[232:235], v22 offset:13312
    ds_read_b128 a[236:239], v23 offset:13312
    ds_read_b128 a[240:243], v20 offset:14336
    ds_read_b128 a[244:247], v21 offset:14336
    ds_read_b128 a[248:251], v22 offset:14336
    ds_read_b128 a[252:255], v23 offset:14336
    s_waitcnt vmcnt(11) lgkmcnt(11)
    v_mfma_f32_32x32x16_bf16 v[112:127], a[160:163], v[64:67], 0
    v_mfma_f32_32x32x16_bf16 v[128:143], a[208:211], v[64:67], 0
    buffer_load_dwordx4 v25, s[12:15], s41 offen  lds
    s_add_u32 m0, m0, s46
    s_waitcnt vmcnt(11) lgkmcnt(10)
    v_mfma_f32_32x32x16_bf16 v[112:127], a[164:167], v[68:71], v[112:127]
    v_mfma_f32_32x32x16_bf16 v[128:143], a[212:215], v[68:71], v[128:143]
    v_max_u32_e64 v11, v67, v71
    buffer_load_dwordx4 v26, s[12:15], s41 offen  lds
    s_add_u32 m0, m0, s46
    s_waitcnt vmcnt(11) lgkmcnt(9)
    v_mfma_f32_32x32x16_bf16 v[112:127], a[168:171], v[72:75], v[112:127]
    v_mfma_f32_32x32x16_bf16 v[128:143], a[216:219], v[72:75], v[128:143]
    buffer_load_dwordx4 v27, s[12:15], s41 offen  lds
    s_add_u32 m0, m0, s46
    s_add_u32 s41, s41, s47
    s_waitcnt vmcnt(11) lgkmcnt(8)
    v_mfma_f32_32x32x16_bf16 v[112:127], a[172:175], v[76:79], v[112:127]
    v_mfma_f32_32x32x16_bf16 v[128:143], a[220:223], v[76:79], v[128:143]
    v_max3_u32 v11, v11, v75, v79
    buffer_load_dwordx4 v25, s[12:15], s41 offen  lds
    s_add_u32 m0, m0, s46
    s_waitcnt vmcnt(11) lgkmcnt(7)
    v_mfma_f32_32x32x16_bf16 v[112:127], a[176:179], v[80:83], v[112:127]
    v_mfma_f32_32x32x16_bf16 v[128:143], a[224:227], v[80:83], v[128:143]
    buffer_load_dwordx4 v26, s[12:15], s41 offen  lds
    s_add_u32 m0, m0, s46
    s_waitcnt vmcnt(11) lgkmcnt(6)
    v_mfma_f32_32x32x16_bf16 v[112:127], a[180:183], v[84:87], v[112:127]
    v_mfma_f32_32x32x16_bf16 v[128:143], a[228:231], v[84:87], v[128:143]
    v_max3_u32 v11, v11, v83, v87
    buffer_load_dwordx4 v27, s[12:15], s41 offen  lds
    s_add_u32 m0, m0, s46
    s_add_u32 s41, s41, s47
    s_waitcnt vmcnt(11) lgkmcnt(5)
    v_mfma_f32_32x32x16_bf16 v[112:127], a[184:187], v[88:91], v[112:127]
    v_mfma_f32_32x32x16_bf16 v[128:143], a[232:235], v[88:91], v[128:143]
    buffer_load_dwordx4 v25, s[12:15], s41 offen  lds
    s_add_u32 m0, m0, s46
    s_waitcnt vmcnt(11) lgkmcnt(4)
    v_mfma_f32_32x32x16_bf16 v[112:127], a[188:191], v[92:95], v[112:127]
    v_mfma_f32_32x32x16_bf16 v[128:143], a[236:239], v[92:95], v[128:143]
    v_max3_u32 v11, v11, v91, v95
    buffer_load_dwordx4 v26, s[12:15], s41 offen  lds
    s_add_u32 m0, m0, s46
    s_waitcnt vmcnt(11) lgkmcnt(3)
    v_mfma_f32_32x32x16_bf16 v[112:127], a[192:195], v[96:99], v[112:127]
    v_mfma_f32_32x32x16_bf16 v[128:143], a[240:243], v[96:99], v[128:143]
    buffer_load_dwordx4 v27, s[12:15], s41 offen  lds
    s_add_u32 m0, m0, s46
    s_add_u32 s41, s41, s47
    s_waitcnt vmcnt(11) lgkmcnt(2)
    v_mfma_f32_32x32x16_bf16 v[112:127], a[196:199], v[100:103], v[112:127]
    v_mfma_f32_32x32x16_bf16 v[128:143], a[244:247], v[100:103], v[128:143]
    v_max3_u32 v11, v11, v99, v103
    buffer_load_dwordx4 v25, s[12:15], s41 offen  lds
    s_add_u32 m0, m0, s46
    s_waitcnt vmcnt(11) lgkmcnt(1)
    v_mfma_f32_32x32x16_bf16 v[112:127], a[200:203], v[104:107], v[112:127]
    v_mfma_f32_32x32x16_bf16 v[128:143], a[248:251], v[104:107], v[128:143]
    buffer_load_dwordx4 v26, s[12:15], s41 offen  lds
    s_add_u32 m0, m0, s46
    s_waitcnt vmcnt(11) lgkmcnt(0)
    v_mfma_f32_32x32x16_bf16 v[112:127], a[204:207], v[108:111], v[112:127]
    v_mfma_f32_32x32x16_bf16 v[128:143], a[252:255], v[108:111], v[128:143]
    v_max3_u32 v11, v11, v107, v111
    buffer_load_dwordx4 v27, s[12:15], s41 offen  lds
    s_add_u32 m0, m0, s46
    s_add_u32 s41, s41, s47
    v_cmp_eq_u32_e64 vcc, -1, v11
    s_cbranch_vccnz L_A_x2_slow
L_A_x2_ok:
    s_nop 9
    ds_write_b128 v28, v[120:123] offset:0
    ds_write_b128 v28, v[124:127] offset:1024
    ds_write_b128 v29, v[128:131] offset:0
    ds_write_b128 v29, v[132:135] offset:1024
    ds_write_b128 v30, v[136:139] offset:0
    ds_write_b128 v30, v[140:143] offset:1024
    s_waitcnt vmcnt(0) lgkmcnt(0)
    s_barrier
    ds_read_b128 v[64:67], v31 offset:0
    ds_read_b128 v[68:71], v31 offset:1024
    ds_read_b128 v[72:75], v31 offset:2048
    ds_read_b128 v[76:79], v31 offset:3072
    ds_read_b128 v[80:83], v31 offset:4096
    ds_read_b128 v[84:87], v31 offset:5120
    buffer_load_dwordx4 v25, s[12:15], s41 offen  lds
    s_add_u32 m0, m0, s46
    s_nop 0
    buffer_load_dwordx4 v26, s[12:15], s41 offen  lds
    s_add_u32 m0, m0, s46
    s_waitcnt lgkmcnt(4)
    v_pk_add_f32 v[112:113], v[112:113], v[64:65]
    v_pk_add_f32 v[114:115], v[114:115], v[66:67]
    v_pk_add_f32 v[116:117], v[116:117], v[68:69]
    v_pk_add_f32 v[118:119], v[118:119], v[70:71]
    s_waitcnt lgkmcnt(2)
    v_pk_add_f32 v[112:113], v[112:113], v[72:73]
    v_pk_add_f32 v[114:115], v[114:115], v[74:75]
    v_pk_add_f32 v[116:117], v[116:117], v[76:77]
    v_pk_add_f32 v[118:119], v[118:119], v[78:79]
    s_waitcnt lgkmcnt(0)
    buffer_load_dwordx4 v27, s[12:15], s41 offen  lds
    s_add_u32 m0, m0, s46
    s_add_u32 s41, s41, s47
    v_pk_add_f32 v[112:113], v[112:113], v[80:81]
    v_pk_add_f32 v[114:115], v[114:115], v[82:83]
    v_pk_add_f32 v[116:117], v[116:117], v[84:85]
    v_pk_add_f32 v[118:119], v[118:119], v[86:87]
    v_max3_f32 v4, v112, v113, v114
    v_max3_f32 v11, v115, v116, v117
    v_max3_f32 v4, v4, v118, v119
    v_max_f32 v4, v4, v11
    v_mov_b32 v11, v4
    s_nop 1
    v_permlane32_swap_b32 v4, v11
    v_max_f32_e64 v4, v4, v11
    buffer_load_dwordx4 v25, s[12:15], s41 offen  lds
    s_add_u32 m0, m0, s46
    v_ceil_f32 v4, v4
    v_sub_f32 v112, v112, v4
    v_sub_f32 v113, v113, v4
    v_sub_f32 v114, v114, v4
    v_sub_f32 v115, v115, v4
    v_sub_f32 v116, v116, v4
    v_sub_f32 v117, v117, v4
    v_sub_f32 v118, v118, v4
    v_sub_f32 v119, v119, v4
    v_exp_f32 v112, v112
    v_exp_f32 v113, v113
    buffer_load_dwordx4 v26, s[12:15], s41 offen  lds
    s_add_u32 m0, m0, s46
    v_exp_f32 v114, v114
    v_exp_f32 v115, v115
    v_exp_f32 v116, v116
    v_exp_f32 v117, v117
    v_exp_f32 v118, v118
    v_exp_f32 v119, v119
    v_min_u32 v4, -2, v4
    v_cvt_pk_bf16_f32 v12, v112, v113
    v_cvt_pk_bf16_f32 v13, v114, v115
    v_cvt_pk_bf16_f32 v14, v116, v117
    v_cvt_pk_bf16_f32 v15, v118, v119
    v_and_b32 v15, 0x7fffffff, v15
    buffer_store_dwordx4 v[12:15], v10, s[16:19], s42 offen
    buffer_store_dword v4, v32, s[16:19], s43 offen
    buffer_load_dwordx4 v27, s[12:15], s41 offen  lds
    s_add_u32 m0, m0, s46
    s_add_u32 s41, s41, s47
    ds_read_b64_tr_b16 a[0:1], v35 offset:0
    ds_read_b64_tr_b16 a[2:3], v35 offset:1536
    ds_read_b64_tr_b16 a[4:5], v35 offset:32
    ds_read_b64_tr_b16 a[6:7], v35 offset:1568
    ds_read_b64_tr_b16 a[8:9], v35 offset:64
    ds_read_b64_tr_b16 a[10:11], v35 offset:1600
    ds_read_b64_tr_b16 a[12:13], v35 offset:768
    buffer_load_dwordx4 v25, s[12:15], s41 offen  lds
    s_add_u32 m0, m0, s46
    ds_read_b64_tr_b16 a[14:15], v35 offset:2304
    ds_read_b64_tr_b16 a[16:17], v35 offset:800
    ds_read_b64_tr_b16 a[18:19], v35 offset:2336
    ds_read_b64_tr_b16 a[20:21], v35 offset:832
    ds_read_b64_tr_b16 a[22:23], v35 offset:2368
    ds_read_b64_tr_b16 a[24:25], v35 offset:3072
    ds_read_b64_tr_b16 a[26:27], v35 offset:4608
    buffer_load_dwordx4 v26, s[12:15], s41 offen  lds
    s_add_u32 m0, m0, s46
    ds_read_b64_tr_b16 a[28:29], v35 offset:3104
    ds_read_b64_tr_b16 a[30:31], v35 offset:4640
    ds_read_b64_tr_b16 a[32:33], v35 offset:3136
    ds_read_b64_tr_b16 a[34:35], v35 offset:4672
    ds_read_b64_tr_b16 a[36:37], v35 offset:3840
    ds_read_b64_tr_b16 a[38:39], v35 offset:5376
    ds_read_b64_tr_b16 a[40:41], v35 offset:3872
    buffer_load_dwordx4 v27, s[12:15], s41 offen  lds
    s_add_u32 m0, m0, s46
    s_add_u32 s41, s41, s47
    ds_read_b64_tr_b16 a[42:43], v35 offset:5408
    ds_read_b64_tr_b16 a[44:45], v35 offset:3904
    ds_read_b64_tr_b16 a[46:47], v35 offset:5440
    ds_read_b64_tr_b16 a[48:49], v35 offset:6144
    ds_read_b64_tr_b16 a[50:51], v35 offset:7680
    ds_read_b64_tr_b16 a[52:53], v35 offset:6176
    ds_read_b64_tr_b16 a[54:55], v35 offset:7712
    buffer_load_dwordx4 v[44:47], v34, s[16:19], s20 offen offset:0 sc1
    buffer_load_dwordx4 v[48:51], v34, s[16:19], s20 offen offset:512 sc1
    buffer_load_dwordx4 v25, s[12:15], s41 offen  lds
    s_add_u32 m0, m0, s46
    ds_read_b64_tr_b16 a[56:57], v35 offset:6208
    ds_read_b64_tr_b16 a[58:59], v35 offset:7744
    ds_read_b64_tr_b16 a[60:61], v35 offset:6912
    ds_read_b64_tr_b16 a[62:63], v35 offset:8448
    ds_read_b64_tr_b16 a[64:65], v35 offset:6944
    ds_read_b64_tr_b16 a[66:67], v35 offset:8480
    ds_read_b64_tr_b16 a[68:69], v35 offset:6976
    buffer_load_dwordx4 v26, s[12:15], s41 offen  lds
    s_add_u32 m0, m0, s46
    ds_read_b64_tr_b16 a[70:71], v35 offset:8512
    ds_read_b64_tr_b16 a[72:73], v35 offset:9216
    ds_read_b64_tr_b16 a[74:75], v35 offset:10752
    ds_read_b64_tr_b16 a[76:77], v35 offset:9248
    ds_read_b64_tr_b16 a[78:79], v35 offset:10784
    ds_read_b64_tr_b16 a[80:81], v35 offset:9280
    ds_read_b64_tr_b16 a[82:83], v35 offset:10816
    buffer_load_dwordx4 v27, s[12:15], s41 offen  lds
    s_add_u32 m0, m0, s46
    s_add_u32 s41, s41, s47
    ds_read_b64_tr_b16 a[84:85], v35 offset:9984
    ds_read_b64_tr_b16 a[86:87], v35 offset:11520
    ds_read_b64_tr_b16 a[88:89], v35 offset:10016
    ds_read_b64_tr_b16 a[90:91], v35 offset:11552
    ds_read_b64_tr_b16 a[92:93], v35 offset:10048
    ds_read_b64_tr_b16 a[94:95], v35 offset:11584
    s_mov_b32 s28, 0
    s_waitcnt vmcnt(3)
    s_branch L_A_m_chk1
L_A_m_loop:
    buffer_load_dwordx4 v[44:47], v34, s[16:19], s20 offen offset:0 sc1
    buffer_load_dwordx4 v[48:51], v34, s[16:19], s20 offen offset:512 sc1
    s_add_u32 s28, s28, 1
    s_cmp_ge_u32 s28, 24
    s_cbranch_scc1 L_A_m_long
L_A_m_chk:
    s_waitcnt vmcnt(0)
L_A_m_chk1:
    v_max3_u32 v11, v44, v45, v46
    v_max3_u32 v11, v11, v47, v48
    v_max3_u32 v11, v11, v49, v50
    v_max_u32 v11, v11, v51
    v_cmp_eq_u32 vcc, -1, v11
    s_cbranch_vccnz L_A_m_loop
L_A_m_ok:
    buffer_load_dwordx4 v[64:67], v33, s[16:19], s44 offen offset:0 sc1
    buffer_load_dwordx4 v[68:71], v33, s[16:19], s44 offen offset:512 sc1
    v_max3_f32 v60, v44, v45, v46
    v_max3_f32 v61, v47, v48, v49
    v_max3_f32 v60, v60, v50, v51
    v_max_f32 v60, v60, v61
    v_mov_b32 v61, v60
    s_nop 1
    v_permlane32_swap_b32 v60, v61
    v_max_f32_e64 v60, v60, v61
    buffer_load_dwordx4 v[72:75], v33, s[16:19], s44 offen offset:1024 sc1
    v_mov_b32 v61, v60
    s_nop 1
    v_permlane16_swap_b32 v60, v61
    v_max_f32 v60, v60, v61
    v_sub_f32 v52, v60, v44
    v_sub_f32 v53, v60, v45
    v_sub_f32 v54, v60, v46
    v_sub_f32 v55, v60, v47
    buffer_load_dwordx4 v[76:79], v33, s[16:19], s44 offen offset:1536 sc1
    v_sub_f32 v56, v60, v48
    v_sub_f32 v57, v60, v49
    v_sub_f32 v58, v60, v50
    v_sub_f32 v59, v60, v51
    v_cvt_pk_u8_f32 v52, v52, 0, 0
    v_cvt_pk_u8_f32 v53, v53, 0, 0
    v_cvt_pk_u8_f32 v54, v54, 0, 0
    buffer_load_dwordx4 v[80:83], v33, s[16:19], s44 offen offset:2048 sc1
    v_cvt_pk_u8_f32 v55, v55, 0, 0
    v_cvt_pk_u8_f32 v56, v56, 0, 0
    v_cvt_pk_u8_f32 v57, v57, 0, 0
    v_cvt_pk_u8_f32 v58, v58, 0, 0
    v_cvt_pk_u8_f32 v59, v59, 0, 0
    v_mul_u32_u24 v52, 0x800080, v52
    v_mul_u32_u24 v53, 0x800080, v53
    buffer_load_dwordx4 v[84:87], v33, s[16:19], s44 offen offset:2560 sc1
    v_mul_u32_u24 v54, 0x800080, v54
    v_mul_u32_u24 v55, 0x800080, v55
    v_mul_u32_u24 v56, 0x800080, v56
    v_mul_u32_u24 v57, 0x800080, v57
    v_mul_u32_u24 v58, 0x800080, v58
    v_mul_u32_u24 v59, 0x800080, v59
    s_waitcnt vmcnt(5) lgkmcnt(0)
    s_barrier
    v_pk_sub_u16 v67, v67, v52 clamp
    v_pk_sub_u16 v64, v64, v52 clamp
    v_pk_sub_u16 v65, v65, v52 clamp
    v_pk_sub_u16 v66, v66, v52 clamp
    buffer_load_dwordx4 v[88:91], v33, s[16:19], s44 offen offset:3072 sc1
    s_waitcnt vmcnt(5)
    v_mfma_f32_16x16x32_bf16 v[136:139], a[0:3], v[64:67], 0
    v_pk_sub_u16 v71, v71, v52 clamp
    v_pk_sub_u16 v68, v68, v52 clamp
    v_mfma_f32_16x16x32_bf16 v[140:143], a[4:7], v[64:67], 0
    v_pk_sub_u16 v69, v69, v52 clamp
    v_pk_sub_u16 v70, v70, v52 clamp
    v_mfma_f32_16x16x32_bf16 v[144:147], a[8:11], v[64:67], 0
    buffer_load_dwordx4 v[92:95], v33, s[16:19], s44 offen offset:3584 sc1
    ds_read_b64_tr_b16 a[96:97], v35 offset:12288
    ds_read_b64_tr_b16 a[98:99], v35 offset:13824
    ds_read_b64_tr_b16 a[100:101], v35 offset:12320
    ds_read_b64_tr_b16 a[102:103], v35 offset:13856
    s_waitcnt vmcnt(5)
    v_mfma_f32_16x16x32_bf16 v[136:139], a[12:15], v[68:71], v[136:139]
    v_pk_sub_u16 v75, v75, v53 clamp
    v_pk_sub_u16 v72, v72, v53 clamp
    v_mfma_f32_16x16x32_bf16 v[140:143], a[16:19], v[68:71], v[140:143]
    v_pk_sub_u16 v73, v73, v53 clamp
    v_pk_sub_u16 v74, v74, v53 clamp
    v_mfma_f32_16x16x32_bf16 v[144:147], a[20:23], v[68:71], v[144:147]
    buffer_load_dwordx4 v[96:99], v33, s[16:19], s45 offen offset:0 sc1
    ds_read_b64_tr_b16 a[104:105], v35 offset:12352
    ds_read_b64_tr_b16 a[106:107], v35 offset:13888
    ds_read_b64_tr_b16 a[108:109], v35 offset:13056
    ds_read_b64_tr_b16 a[110:111], v35 offset:14592
    s_waitcnt vmcnt(5)
    v_mfma_f32_16x16x32_bf16 v[136:139], a[24:27], v[72:75], v[136:139]
    v_pk_sub_u16 v79, v79, v53 clamp
    v_pk_sub_u16 v76, v76, v53 clamp
    v_mfma_f32_16x16x32_bf16 v[140:143], a[28:31], v[72:75], v[140:143]
    v_pk_sub_u16 v77, v77, v53 clamp
    v_pk_sub_u16 v78, v78, v53 clamp
    v_mfma_f32_16x16x32_bf16 v[144:147], a[32:35], v[72:75], v[144:147]
    buffer_load_dwordx4 v[100:103], v33, s[16:19], s45 offen offset:512 sc1
    ds_read_b64_tr_b16 a[112:113], v35 offset:13088
    ds_read_b64_tr_b16 a[114:115], v35 offset:14624
    ds_read_b64_tr_b16 a[116:117], v35 offset:13120
    ds_read_b64_tr_b16 a[118:119], v35 offset:14656
    s_waitcnt vmcnt(5)
    v_mfma_f32_16x16x32_bf16 v[136:139], a[36:39], v[76:79], v[136:139]
    v_pk_sub_u16 v83, v83, v54 clamp
    v_pk_sub_u16 v80, v80, v54 clamp
    v_mfma_f32_16x16x32_bf16 v[140:143], a[40:43], v[76:79], v[140:143]
    v_pk_sub_u16 v81, v81, v54 clamp
    v_pk_sub_u16 v82, v82, v54 clamp
    v_mfma_f32_16x16x32_bf16 v[144:147], a[44:47], v[76:79], v[144:147]
    buffer_load_dwordx4 v[104:107], v33, s[16:19], s45 offen offset:1024 sc1
    ds_read_b64_tr_b16 a[120:121], v35 offset:15360
    ds_read_b64_tr_b16 a[122:123], v35 offset:16896
    ds_read_b64_tr_b16 a[124:125], v35 offset:15392
    ds_read_b64_tr_b16 a[126:127], v35 offset:16928
    s_waitcnt vmcnt(5)
    v_mfma_f32_16x16x32_bf16 v[136:139], a[48:51], v[80:83], v[136:139]
    v_pk_sub_u16 v87, v87, v54 clamp
    v_pk_sub_u16 v84, v84, v54 clamp
    v_mfma_f32_16x16x32_bf16 v[140:143], a[52:55], v[80:83], v[140:143]
    v_pk_sub_u16 v85, v85, v54 clamp
    v_pk_sub_u16 v86, v86, v54 clamp
    v_mfma_f32_16x16x32_bf16 v[144:147], a[56:59], v[80:83], v[144:147]
    buffer_load_dwordx4 v[108:111], v33, s[16:19], s45 offen offset:1536 sc1
    ds_read_b64_tr_b16 a[128:129], v35 offset:15424
    ds_read_b64_tr_b16 a[130:131], v35 offset:16960
    ds_read_b64_tr_b16 a[132:133], v35 offset:16128
    ds_read_b64_tr_b16 a[134:135], v35 offset:17664
    s_waitcnt vmcnt(5)
    v_mfma_f32_16x16x32_bf16 v[136:139], a[60:63], v[84:87], v[136:139]
    v_pk_sub_u16 v91, v91, v55 clamp
    v_pk_sub_u16 v88, v88, v55 clamp
    v_mfma_f32_16x16x32_bf16 v[140:143], a[64:67], v[84:87], v[140:143]
    v_pk_sub_u16 v89, v89, v55 clamp
    v_pk_sub_u16 v90, v90, v55 clamp
    v_mfma_f32_16x16x32_bf16 v[144:147], a[68:71], v[84:87], v[144:147]
    buffer_load_dwordx4 v[112:115], v33, s[16:19], s45 offen offset:2048 sc1
    ds_read_b64_tr_b16 a[136:137], v35 offset:16160
    ds_read_b64_tr_b16 a[138:139], v35 offset:17696
    ds_read_b64_tr_b16 a[140:141], v35 offset:16192
    ds_read_b64_tr_b16 a[142:143], v35 offset:17728
    s_waitcnt vmcnt(5)
    v_mfma_f32_16x16x32_bf16 v[136:139], a[72:75], v[88:91], v[136:139]
    v_pk_sub_u16 v95, v95, v55 clamp
    v_pk_sub_u16 v92, v92, v55 clamp
    v_mfma_f32_16x16x32_bf16 v[140:143], a[76:79], v[88:91], v[140:143]
    v_pk_sub_u16 v93, v93, v55 clamp
    v_pk_sub_u16 v94, v94, v55 clamp
    v_mfma_f32_16x16x32_bf16 v[144:147], a[80:83], v[88:91], v[144:147]
    buffer_load_dwordx4 v[116:119], v33, s[16:19], s45 offen offset:2560 sc1
    ds_read_b64_tr_b16 a[144:145], v35 offset:18432
    ds_read_b64_tr_b16 a[146:147], v35 offset:19968
    ds_read_b64_tr_b16 a[148:149], v35 offset:18464
    ds_read_b64_tr_b16 a[150:151], v35 offset:20000
    s_waitcnt vmcnt(5)
    v_mfma_f32_16x16x32_bf16 v[136:139], a[84:87], v[92:95], v[136:139]
    v_pk_sub_u16 v99, v99, v56 clamp
    v_pk_sub_u16 v96, v96, v56 clamp
    v_mfma_f32_16x16x32_bf16 v[140:143], a[88:91], v[92:95], v[140:143]
    v_pk_sub_u16 v97, v97, v56 clamp
    v_pk_sub_u16 v98, v98, v56 clamp
    v_mfma_f32_16x16x32_bf16 v[144:147], a[92:95], v[92:95], v[144:147]
    buffer_load_dwordx4 v[120:123], v33, s[16:19], s45 offen offset:3072 sc1
    ds_read_b64_tr_b16 a[152:153], v35 offset:18496
    ds_read_b64_tr_b16 a[154:155], v35 offset:20032
    ds_read_b64_tr_b16 a[156:157], v35 offset:19200
    ds_read_b64_tr_b16 a[158:159], v35 offset:20736
    s_waitcnt vmcnt(5) lgkmcnt(15)
    v_mfma_f32_16x16x32_bf16 v[136:139], a[96:99], v[96:99], v[136:139]
    v_pk_sub_u16 v103, v103, v56 clamp
    v_pk_sub_u16 v100, v100, v56 clamp
    v_mfma_f32_16x16x32_bf16 v[140:143], a[100:103], v[96:99], v[140:143]
    v_pk_sub_u16 v101, v101, v56 clamp
    v_pk_sub_u16 v102, v102, v56 clamp
    v_mfma_f32_16x16x32_bf16 v[144:147], a[104:107], v[96:99], v[144:147]
    buffer_load_dwordx4 v[124:127], v33, s[16:19], s45 offen offset:3584 sc1
    ds_read_b64_tr_b16 a[160:161], v35 offset:19232
    ds_read_b64_tr_b16 a[162:163], v35 offset:20768
    ds_read_b64_tr_b16 a[164:165], v35 offset:19264
    ds_read_b64_tr_b16 a[166:167], v35 offset:20800
    s_waitcnt vmcnt(5) lgkmcnt(15)
    v_mfma_f32_16x16x32_bf16 v[136:139], a[108:111], v[100:103], v[136:139]
    v_pk_sub_u16 v107, v107, v57 clamp
    v_pk_sub_u16 v104, v104, v57 clamp
    v_mfma_f32_16x16x32_bf16 v[140:143], a[112:115], v[100:103], v[140:143]
    v_pk_sub_u16 v105, v105, v57 clamp
    v_pk_sub_u16 v106, v106, v57 clamp
    v_mfma_f32_16x16x32_bf16 v[144:147], a[116:119], v[100:103], v[144:147]
    v_or3_b32 v11, v67, v71, v75
    ds_read_b64_tr_b16 a[168:169], v35 offset:21504
    ds_read_b64_tr_b16 a[170:171], v35 offset:23040
    ds_read_b64_tr_b16 a[172:173], v35 offset:21536
    ds_read_b64_tr_b16 a[174:175], v35 offset:23072
    s_waitcnt vmcnt(4) lgkmcnt(15)
    v_mfma_f32_16x16x32_bf16 v[136:139], a[120:123], v[104:107], v[136:139]
    v_pk_sub_u16 v111, v111, v57 clamp
    v_pk_sub_u16 v108, v108, v57 clamp
    v_mfma_f32_16x16x32_bf16 v[140:143], a[124:127], v[104:107], v[140:143]
    v_pk_sub_u16 v109, v109, v57 clamp
    v_pk_sub_u16 v110, v110, v57 clamp
    v_mfma_f32_16x16x32_bf16 v[144:147], a[128:131], v[104:107], v[144:147]
    v_or3_b32 v11, v11, v79, v83
    ds_read_b64_tr_b16 a[176:177], v35 offset:21568
    ds_read_b64_tr_b16 a[178:179], v35 offset:23104
    ds_read_b64_tr_b16 a[180:181], v35 offset:22272
    ds_read_b64_tr_b16 a[182:183], v35 offset:23808
    s_waitcnt vmcnt(3) lgkmcnt(15)
    v_mfma_f32_16x16x32_bf16 v[136:139], a[132:135], v[108:111], v[136:139]
    v_pk_sub_u16 v115, v115, v58 clamp
    v_pk_sub_u16 v112, v112, v58 clamp
    v_mfma_f32_16x16x32_bf16 v[140:143], a[136:139], v[108:111], v[140:143]
    v_pk_sub_u16 v113, v113, v58 clamp
    v_pk_sub_u16 v114, v114, v58 clamp
    v_mfma_f32_16x16x32_bf16 v[144:147], a[140:143], v[108:111], v[144:147]
    v_or3_b32 v11, v11, v87, v91
    ds_read_b64_tr_b16 a[184:185], v35 offset:22304
    ds_read_b64_tr_b16 a[186:187], v35 offset:23840
    ds_read_b64_tr_b16 a[188:189], v35 offset:22336
    ds_read_b64_tr_b16 a[190:191], v35 offset:23872
    s_waitcnt vmcnt(2) lgkmcnt(15)
    v_mfma_f32_16x16x32_bf16 v[136:139], a[144:147], v[112:115], v[136:139]
    v_pk_sub_u16 v119, v119, v58 clamp
    v_pk_sub_u16 v116, v116, v58 clamp
    v_mfma_f32_16x16x32_bf16 v[140:143], a[148:151], v[112:115], v[140:143]
    v_pk_sub_u16 v117, v117, v58 clamp
    v_pk_sub_u16 v118, v118, v58 clamp
    v_mfma_f32_16x16x32_bf16 v[144:147], a[152:155], v[112:115], v[144:147]
    v_or3_b32 v11, v11, v95, v99
    s_waitcnt vmcnt(1) lgkmcnt(12)
    v_mfma_f32_16x16x32_bf16 v[136:139], a[156:159], v[116:119], v[136:139]
    v_pk_sub_u16 v123, v123, v59 clamp
    v_pk_sub_u16 v120, v120, v59 clamp
    v_mfma_f32_16x16x32_bf16 v[140:143], a[160:163], v[116:119], v[140:143]
    v_pk_sub_u16 v121, v121, v59 clamp
    v_pk_sub_u16 v122, v122, v59 clamp
    v_mfma_f32_16x16x32_bf16 v[144:147], a[164:167], v[116:119], v[144:147]
    buffer_atomic_add v161, v162, s[16:19], s81 offen sc1
    s_waitcnt vmcnt(1) lgkmcnt(6)
    v_mfma_f32_16x16x32_bf16 v[136:139], a[168:171], v[120:123], v[136:139]
    v_pk_sub_u16 v127, v127, v59 clamp
    v_pk_sub_u16 v124, v124, v59 clamp
    v_mfma_f32_16x16x32_bf16 v[140:143], a[172:175], v[120:123], v[140:143]
    v_pk_sub_u16 v125, v125, v59 clamp
    v_pk_sub_u16 v126, v126, v59 clamp
    v_mfma_f32_16x16x32_bf16 v[144:147], a[176:179], v[120:123], v[144:147]
    v_or3_b32 v11, v11, v103, v107
    s_waitcnt lgkmcnt(0)
    v_mfma_f32_16x16x32_bf16 v[136:139], a[180:183], v[124:127], v[136:139]
    v_or3_b32 v11, v11, v111, v115
    v_or3_b32 v11, v11, v119, v123
    v_mfma_f32_16x16x32_bf16 v[140:143], a[184:187], v[124:127], v[140:143]
    v_or_b32_e64 v11, v11, v127
    v_mfma_f32_16x16x32_bf16 v[144:147], a[188:191], v[124:127], v[144:147]
    v_cmp_gt_i32_e64 vcc, 0, v11
    s_cbranch_vccnz L_A_p_slow
L_A_p_ok:
    v_mfma_f32_16x16x32_bf16 v[148:151], v[40:43], v[64:67], 0
    v_mfma_f32_16x16x32_bf16 v[148:151], v[40:43], v[68:71], v[148:151]
    v_mfma_f32_16x16x32_bf16 v[148:151], v[40:43], v[72:75], v[148:151]
    s_nop 1
    v_cvt_pk_bf16_f32 v136, v136, v137
    ds_permute_b32 v44, v36, v136
    v_mfma_f32_16x16x32_bf16 v[148:151], v[40:43], v[76:79], v[148:151]
    v_cvt_pk_bf16_f32 v137, v138, v139
    v_min_u32_e64 v137, -2, v137
    v_mfma_f32_16x16x32_bf16 v[148:151], v[40:43], v[80:83], v[148:151]
    ds_permute_b32 v45, v36, v137
    v_cvt_pk_bf16_f32 v138, v140, v141
    v_mfma_f32_16x16x32_bf16 v[148:151], v[40:43], v[84:87], v[148:151]
    ds_permute_b32 v46, v36, v138
    v_cvt_pk_bf16_f32 v139, v142, v143
    v_mfma_f32_16x16x32_bf16 v[148:151], v[40:43], v[88:91], v[148:151]
    v_min_u32_e64 v139, -2, v139
    ds_permute_b32 v47, v36, v139
    v_mfma_f32_16x16x32_bf16 v[148:151], v[40:43], v[92:95], v[148:151]
    v_cvt_pk_bf16_f32 v140, v144, v145
    ds_permute_b32 v48, v36, v140
    v_mfma_f32_16x16x32_bf16 v[148:151], v[40:43], v[96:99], v[148:151]
    v_cvt_pk_bf16_f32 v141, v146, v147
    v_min_u32_e64 v141, -2, v141
    v_mfma_f32_16x16x32_bf16 v[148:151], v[40:43], v[100:103], v[148:151]
    ds_permute_b32 v49, v36, v141
    v_mfma_f32_16x16x32_bf16 v[148:151], v[40:43], v[104:107], v[148:151]
    v_mfma_f32_16x16x32_bf16 v[148:151], v[40:43], v[108:111], v[148:151]
    s_waitcnt lgkmcnt(2)
    v_mfma_f32_16x16x32_bf16 v[148:151], v[40:43], v[112:115], v[148:151]
    buffer_store_dwordx4 v[44:47], v37, s[16:19], s21 offen sc1
    s_waitcnt lgkmcnt(0)
    v_mfma_f32_16x16x32_bf16 v[148:151], v[40:43], v[116:119], v[148:151]
    buffer_store_dwordx2 v[48:49], v38, s[16:19], s22 offen sc1
    v_mfma_f32_16x16x32_bf16 v[148:151], v[40:43], v[120:123], v[148:151]
    v_mfma_f32_16x16x32_bf16 v[148:151], v[40:43], v[124:127], v[148:151]
    s_nop 7
    v_min_u32 v61, -2, v148
    buffer_store_dwordx2 v[60:61], v39, s[16:19], s35 offen sc1
    s_load_dword s80, s[16:17], s80
    s_waitcnt lgkmcnt(0)
    s_cmp_eq_u32 s80, 31
    s_cbranch_scc1 L_A_nore
    s_waitcnt vmcnt(0)
    buffer_store_dwordx4 v[12:15], v10, s[16:19], s42 offen sc1
    buffer_store_dword v4, v32, s[16:19], s43 offen sc1
L_A_nore:
    s_cmp_lg_u32 s3, 0
    s_cbranch_scc1 L_A_end
    s_cmp_ge_u32 s25, 5
    s_cbranch_scc1 L_A_end
    s_mul_i32 s35, s24, 5
    s_add_u32 s35, s35, s25
    v_and_b32_e64 v5, 3, v1
    v_lshlrev_b32 v3, 1, v19
    v_lshl_add_u32 v48, v5, 3, v3
    s_lshl_b32 s40, s35, 5
    buffer_load_ushort v49, v48, s[4:7], s40 offen
    buffer_load_ushort v50, v48, s[8:11], s40 offen
    v_and_b32_e64 v3, 12, v1
    v_lshl_or_b32 v57, v3, 20, v48
    v_lshrrev_b32_e64 v3, 2, v1
    v_mul_u32_u24 v56, 2560, v3
    v_lshl_add_u32 v56, v5, 4, v56
    s_lshl_b32 s27, s35, 7
    s_add_u32 s27, s27, 1376256
    s_add_u32 s90, s16, s27
    s_addc_u32 s91, s17, 0
    s_lshl_b32 s41, s35, 6
    s_add_u32 s41, s41, 2555904
    s_add_u32 s42, s41, 40960
    s_mov_b32 s28, 0
L_Z_y:
    buffer_load_dwordx4 v[64:67], v56, s[16:19], s41 offen sc1
    buffer_load_dwordx4 v[68:71], v56, s[16:19], s42 offen sc1
    s_add_u32 s28, s28, 1
    s_waitcnt vmcnt(0)
    v_max_u32 v3, v67, v71
    v_pk_add_f32 v[60:61], v[64:65], v[68:69]
    v_pk_add_f32 v[62:63], v[66:67], v[70:71]
    v_cmp_eq_u32 vcc, -1, v3
    s_cbranch_vccnz L_Z_y_r
L_Z_y_ok:
    v_permlane32_swap_b32 v60, v62
    v_permlane32_swap_b32 v61, v63
    v_add_f32 v60, v60, v62
    v_add_f32 v61, v61, v63
    s_nop 1
    v_permlane16_swap_b32 v60, v61
    v_add_f32_e64 v60, v60, v61
    s_nop 1
    v_add_f32 v60, v60, v60 row_ror:8 row_mask:0xf bank_mask:0xf
    s_nop 1
    v_add_f32 v60, v60, v60 row_ror:4 row_mask:0xf bank_mask:0xf
    v_cvt_pk_bf16_f32 v60, v60, v60
    v_and_b32 v60, 0xffff0000, v60
    s_cmp_eq_u32 s35, 0
    s_cselect_b32 s27, 1, 0
    v_cmp_gt_u32_e64 vcc, s27, v1
    v_mov_b32 v4, 0x20000000
    s_nop 0
    v_cndmask_b32 v4, v4, v1, vcc
    v_mov_b32 v5, s26
    buffer_store_dword v5, v4, s[16:19], 0 offen offset:0 sc1
    s_lshl_b32 s41, s35, 6
    s_add_u32 s41, s41, 2228224
    s_add_u32 s42, s41, 40960
    s_add_u32 s43, s41, 81920
    s_add_u32 s44, s41, 122880
    s_add_u32 s45, s41, 163840
    s_add_u32 s46, s41, 204800
    s_add_u32 s47, s41, 245760
    s_add_u32 s39, s41, 286720
    v_lshlrev_b32 v50, 16, v50
    v_add_f32 v50, v50, v60
    v_cvt_pk_bf16_f32 v50, v50, v50
    v_and_b32 v50, 0xffff0000, v50
    v_mul_f32 v3, 0xbfb8aa3b, v50
    v_exp_f32 v3, v3
    s_nop 0
    v_add_f32 v3, 1.0, v3
    v_rcp_f32 v3, v3
    s_nop 0
    v_mul_f32 v50, v50, v3
    v_cvt_pk_bf16_f32 v50, v50, v50
    v_and_b32 v50, 0xffff0000, v50
    v_lshlrev_b32_e64 v49, 16, v49
    s_mov_b32 s28, 0
L_Z_n5:
    s_load_dword s92, s[90:91], 0 glc
    s_add_u32 s28, s28, 1
    s_cmp_ge_u32 s28, 200000
    s_waitcnt lgkmcnt(0)
    s_cbranch_scc1 L_Z_n5_out
    s_cmp_lt_i32 s92, 31
    s_cbranch_scc1 L_Z_n5
L_Z_n5_out:
L_Z_s:
    buffer_load_dwordx4 v[64:67], v56, s[16:19], s41 offen sc1
    buffer_load_dwordx4 v[68:71], v56, s[16:19], s42 offen sc1
    buffer_load_dwordx4 v[72:75], v56, s[16:19], s43 offen sc1
    buffer_load_dwordx4 v[76:79], v56, s[16:19], s44 offen sc1
    buffer_load_dwordx4 v[80:83], v56, s[16:19], s45 offen sc1
    buffer_load_dwordx4 v[84:87], v56, s[16:19], s46 offen sc1
    buffer_load_dwordx4 v[88:91], v56, s[16:19], s47 offen sc1
    buffer_load_dwordx4 v[92:95], v56, s[16:19], s39 offen sc1
    s_add_u32 s28, s28, 1
    s_waitcnt vmcnt(6)
    v_max_u32_e64 v3, v67, v71
    v_pk_add_f32 v[60:61], v[64:65], v[68:69]
    v_pk_add_f32 v[62:63], v[66:67], v[70:71]
    s_waitcnt vmcnt(5)
    v_max_u32 v3, v3, v75
    v_pk_add_f32 v[60:61], v[60:61], v[72:73]
    v_pk_add_f32 v[62:63], v[62:63], v[74:75]
    s_waitcnt vmcnt(4)
    v_max_u32 v3, v3, v79
    v_pk_add_f32 v[60:61], v[60:61], v[76:77]
    v_pk_add_f32 v[62:63], v[62:63], v[78:79]
    s_waitcnt vmcnt(3)
    v_max_u32 v3, v3, v83
    v_pk_add_f32 v[60:61], v[60:61], v[80:81]
    v_pk_add_f32 v[62:63], v[62:63], v[82:83]
    s_waitcnt vmcnt(2)
    v_max_u32 v3, v3, v87
    v_pk_add_f32 v[60:61], v[60:61], v[84:85]
    v_pk_add_f32 v[62:63], v[62:63], v[86:87]
    s_waitcnt vmcnt(1)
    v_max_u32 v3, v3, v91
    v_pk_add_f32 v[60:61], v[60:61], v[88:89]
    v_pk_add_f32 v[62:63], v[62:63], v[90:91]
    s_waitcnt vmcnt(0)
    v_max_u32 v3, v3, v95
    v_pk_add_f32 v[60:61], v[60:61], v[92:93]
    v_pk_add_f32 v[62:63], v[62:63], v[94:95]
    v_cmp_eq_u32 vcc, -1, v3
    s_cbranch_vccnz L_Z_s_r
L_Z_s_ok:
    v_permlane32_swap_b32 v60, v62
    v_permlane32_swap_b32 v61, v63
    v_add_f32 v60, v60, v62
    v_add_f32 v61, v61, v63
    s_nop 1
    v_permlane16_swap_b32 v60, v61
    v_add_f32_e64 v60, v60, v61
    s_nop 1
    v_add_f32 v60, v60, v60 row_ror:8 row_mask:0xf bank_mask:0xf
    s_nop 1
    v_add_f32 v60, v60, v60 row_ror:4 row_mask:0xf bank_mask:0xf
    v_cvt_pk_bf16_f32 v60, v60, v60
    v_and_b32 v60, 0xffff0000, v60
    v_mul_f32_e64 v60, v60, v50
    v_cvt_pk_bf16_f32 v60, v60, v60
    v_and_b32 v60, 0xffff0000, v60
    v_add_f32_e64 v60, v60, v49
    v_cvt_pk_bf16_f32 v60, v60, v60
    buffer_store_short v60, v57, s[84:87], s40 offen
L_A_end:
    s_endpgm
.p2align 8
L_F:
    v_lshrrev_b32_e64 v2, 6, v0
    v_and_b32 v1, 63, v0
    v_readfirstlane_b32 s3, v2
    s_and_b32 s24, s2, 3
    s_bfe_u32 s27, s2, 0x10002
    s_lshl1_add_u32 s24, s24, s27
    s_mov_b32 s18, 268435456
    s_mov_b32 s19, 0x20000
    s_mov_b32 s6, 1280
    s_mov_b32 s7, 0x20000
    s_sub_u32 s25, s25, 16
    s_lshl_b32 s89, s24, 2
    s_add_u32 s89, s89, s25
    s_sub_u32 s89, s89, 12
    v_lshrrev_b32 v2, 3, v1
    v_and_b32 v5, 7, v1
    v_lshlrev_b32 v7, 1, v2
    s_and_b32 s46, s25, 3
    s_lshl_b32 s46, s46, 2
    s_add_u32 s46, s46, s3
    s_mul_i32 s35, s46, 80
    s_mul_i32 s42, s89, 3072
    s_add_u32 s42, s42, 1245184
    v_lshlrev_b32_e64 v14, 4, v0
    v_and_b32 v16, 0x7ff, v14
    v_mov_b32 v60, -1
    v_mov_b32 v61, -1
    v_mov_b32 v62, -1
    v_mov_b32 v63, -1
    s_mul_i32 s36, s89, 18432
    s_add_u32 s36, s36, 262144
    s_mul_i32 s38, s89, 40960
    s_add_u32 s38, s38, 1343488
    s_add_u32 s39, s38, 40960
    s_waitcnt lgkmcnt(0)
    s_load_dword s26, s[16:17], 0
    s_load_dwordx2 s[30:31], s[0:1], 96
    v_min_u32 v17, 3056, v14
    buffer_store_dwordx4 v[60:63], v17, s[16:19], s42 offen sc1
    v_lshlrev_b32 v3, 4, v1
    v_lshlrev_b32_e64 v4, 2, v1
    buffer_load_dwordx4 v[8:11], v3, s[4:7], 0 offen
    buffer_load_dword v12, v4, s[4:7], 0 offen offset:1024
    buffer_load_ushort v88, v7, s[4:7], s35 offen offset:0
    buffer_load_ushort v89, v7, s[4:7], s35 offen offset:16
    buffer_load_ushort v90, v7, s[4:7], s35 offen offset:32
    buffer_load_ushort v91, v7, s[4:7], s35 offen offset:48
    buffer_load_ushort v92, v7, s[4:7], s35 offen offset:64
    s_load_dwordx2 s[12:13], s[0:1], 56
    s_load_dwordx2 s[8:9], s[0:1], 72
    s_load_dwordx2 s[96:97], s[0:1], 64
    s_load_dwordx2 s[20:21], s[0:1], 40
    v_and_b32 v3, 1, v1
    v_lshlrev_b32 v3, 4, v3
    v_mov_b32 v4, 0xffff
    v_lshlrev_b32_e64 v3, v3, v4
    v_bfe_u32 v4, v1, 1, 2
    v_cmp_eq_u32 vcc, 0, v4
    s_nop 1
    v_cndmask_b32 v152, 0, v3, vcc
    v_cmp_eq_u32 vcc, 1, v4
    s_nop 1
    v_cndmask_b32 v153, 0, v3, vcc
    v_cmp_eq_u32 vcc, 2, v4
    s_nop 1
    v_cndmask_b32 v154, 0, v3, vcc
    v_cmp_eq_u32 vcc, 3, v4
    s_nop 1
    v_cndmask_b32 v155, 0, v3, vcc
    s_waitcnt vmcnt(7) lgkmcnt(0)
    s_barrier
    s_mov_b32 s94, 1
    s_cmp_lg_u32 s3, 0
    s_cbranch_scc1 L_F0_noadd
    s_atomic_add s94, s[30:31], 0
L_F0_noadd:
    s_mov_b32 s27, s36
    buffer_store_dwordx4 v[60:63], v14, s[16:19], s27 offen sc1
    s_add_u32 s27, s27, 4096
    buffer_store_dwordx4 v[60:63], v14, s[16:19], s27 offen sc1
    s_add_u32 s27, s27, 4096
    buffer_store_dwordx4 v[60:63], v14, s[16:19], s27 offen sc1
    s_add_u32 s27, s27, 4096
    buffer_store_dwordx4 v[60:63], v14, s[16:19], s27 offen sc1
    s_add_u32 s27, s27, 4096
    buffer_store_dwordx4 v[60:63], v16, s[16:19], s27 offen sc1
    s_add_u32 s27, s27, 4096
L_F_clr:
    buffer_store_dwordx4 v[60:63], v14, s[16:19], s38 offen sc1
    s_add_u32 s38, s38, 4096
    s_cmp_lt_u32 s38, s39
    s_cbranch_scc1 L_F_clr
    s_mul_i32 s26, s26, 0x9e3779b1
    s_add_u32 s26, s26, 0x7f4a7c15
    s_mov_b32 s14, 1966080
    s_mov_b32 s15, 0x20000
    s_mov_b32 s22, 7864320
    s_mov_b32 s23, 0x20000
    s_waitcnt vmcnt(15)
    v_lshlrev_b32 v24, 16, v8
    v_and_b32 v25, 0xffff0000, v8
    v_lshlrev_b32_e64 v26, 16, v9
    v_and_b32 v27, 0xffff0000, v9
    v_lshlrev_b32_e64 v28, 16, v10
    v_and_b32 v29, 0xffff0000, v10
    v_lshlrev_b32_e64 v30, 16, v11
    v_and_b32 v31, 0xffff0000, v11
    v_lshlrev_b32_e64 v32, 16, v12
    v_and_b32 v33, 0xffff0000, v12
    v_add_f32 v34, v24, v25
    v_add_f32 v34, v34, v26
    v_add_f32 v34, v34, v27
    v_add_f32 v34, v34, v28
    v_add_f32 v34, v34, v29
    v_add_f32 v34, v34, v30
    v_add_f32 v34, v34, v31
    v_add_f32 v34, v34, v32
    v_add_f32 v34, v34, v33
    s_nop 1
    v_add_f32 v34, v34, v34 quad_perm:[1,0,3,2] row_mask:0xf bank_mask:0xf
    s_nop 1
    v_add_f32 v34, v34, v34 quad_perm:[2,3,0,1] row_mask:0xf bank_mask:0xf
    s_nop 1
    v_add_f32 v34, v34, v34 row_half_mirror row_mask:0xf bank_mask:0xf
    s_nop 1
    v_add_f32 v34, v34, v34 row_mirror row_mask:0xf bank_mask:0xf
    s_nop 1
    v_add_f32 v34, v34, v34 row_bcast:15 row_mask:0xa bank_mask:0xf
    s_nop 1
    v_add_f32 v34, v34, v34 row_bcast:31 row_mask:0xc bank_mask:0xf
    s_nop 0
    v_readlane_b32 s32, v34, 63
    v_mov_b32 v34, 0x3acccccd
    s_nop 0
    v_mul_f32 v34, s32, v34
    v_sub_f32 v24, v24, v34
    v_sub_f32 v25, v25, v34
    v_sub_f32 v26, v26, v34
    v_sub_f32 v27, v27, v34
    v_sub_f32 v28, v28, v34
    v_sub_f32 v29, v29, v34
    v_sub_f32 v30, v30, v34
    v_sub_f32 v31, v31, v34
    v_sub_f32 v32, v32, v34
    v_sub_f32 v33, v33, v34
    v_mul_f32 v35, v24, v24
    v_fmac_f32 v35, v25, v25
    v_fmac_f32 v35, v26, v26
    v_fmac_f32 v35, v27, v27
    v_fmac_f32 v35, v28, v28
    v_fmac_f32 v35, v29, v29
    v_fmac_f32 v35, v30, v30
    v_fmac_f32 v35, v31, v31
    v_fmac_f32_e64 v35, v32, v32
    v_fmac_f32 v35, v33, v33
    s_nop 1
    v_add_f32 v35, v35, v35 quad_perm:[1,0,3,2] row_mask:0xf bank_mask:0xf
    s_nop 1
    v_add_f32 v35, v35, v35 quad_perm:[2,3,0,1] row_mask:0xf bank_mask:0xf
    s_nop 1
    v_add_f32 v35, v35, v35 row_half_mirror row_mask:0xf bank_mask:0xf
    s_nop 1
    v_add_f32 v35, v35, v35 row_mirror row_mask:0xf bank_mask:0xf
    s_nop 1
    v_add_f32 v35, v35, v35 row_bcast:15 row_mask:0xa bank_mask:0xf
    s_nop 1
    v_add_f32 v35, v35, v35 row_bcast:31 row_mask:0xc bank_mask:0xf
    s_nop 0
    v_readlane_b32 s33, v35, 63
    v_mov_b32 v35, 0x3acccccd
    s_nop 0
    v_mul_f32 v35, s33, v35
    v_cvt_pk_bf16_f32 v34, v34, v34
    v_and_b32 v34, 0xffff0000, v34
    v_cvt_pk_bf16_f32 v35, v35, v35
    v_and_b32 v35, 0xffff0000, v35
    v_add_f32 v35, 0x3727c5ac, v35
    v_cvt_pk_bf16_f32 v35, v35, v35
    v_and_b32 v35, 0xffff0000, v35
    v_sqrt_f32 v35, v35
    v_readfirstlane_b32 s32, v34
    v_cvt_pk_bf16_f32 v35, v35, v35
    v_and_b32 v35, 0xffff0000, v35
    v_rcp_f32 v34, v35
    v_readfirstlane_b32 s33, v35
    v_readfirstlane_b32 s34, v34
    v_lshlrev_b32 v88, 16, v88
    v_subrev_f32_e64 v88, s32, v88
    v_cvt_pk_bf16_f32 v88, v88, v88
    v_and_b32 v88, 0xffff0000, v88
    v_mul_f32_e64 v3, s34, v88
    v_fma_f32 v88, -v3, s33, v88
    v_fmac_f32_e64 v3, s34, v88
    v_cvt_pk_bf16_f32 v88, v3, v3
    v_and_b32 v24, v88, v152
    v_and_b32 v25, v88, v153
    v_and_b32 v26, v88, v154
    v_and_b32 v27, v88, v155
    v_lshlrev_b32 v89, 16, v89
    v_subrev_f32 v89, s32, v89
    v_cvt_pk_bf16_f32 v89, v89, v89
    v_and_b32 v89, 0xffff0000, v89
    v_mul_f32_e64 v3, s34, v89
    v_fma_f32 v89, -v3, s33, v89
    v_fmac_f32_e64 v3, s34, v89
    v_cvt_pk_bf16_f32 v89, v3, v3
    v_and_b32 v28, v89, v152
    v_and_b32 v29, v89, v153
    v_and_b32 v30, v89, v154
    v_and_b32 v31, v89, v155
    v_lshlrev_b32 v90, 16, v90
    v_subrev_f32 v90, s32, v90
    v_cvt_pk_bf16_f32 v90, v90, v90
    v_and_b32 v90, 0xffff0000, v90
    v_mul_f32_e64 v3, s34, v90
    v_fma_f32 v90, -v3, s33, v90
    v_fmac_f32_e64 v3, s34, v90
    v_cvt_pk_bf16_f32 v90, v3, v3
    v_and_b32 v32, v90, v152
    v_and_b32 v33, v90, v153
    v_and_b32 v34, v90, v154
    v_and_b32 v35, v90, v155
    v_lshlrev_b32 v91, 16, v91
    v_subrev_f32 v91, s32, v91
    v_cvt_pk_bf16_f32 v91, v91, v91
    v_and_b32 v91, 0xffff0000, v91
    v_mul_f32_e64 v3, s34, v91
    v_fma_f32 v91, -v3, s33, v91
    v_fmac_f32_e64 v3, s34, v91
    v_cvt_pk_bf16_f32 v91, v3, v3
    v_and_b32 v36, v91, v152
    v_and_b32 v37, v91, v153
    v_and_b32 v38, v91, v154
    v_and_b32 v39, v91, v155
    v_lshlrev_b32 v92, 16, v92
    v_subrev_f32 v92, s32, v92
    v_cvt_pk_bf16_f32 v92, v92, v92
    v_and_b32 v92, 0xffff0000, v92
    v_mul_f32_e64 v3, s34, v92
    v_fma_f32 v92, -v3, s33, v92
    v_fmac_f32_e64 v3, s34, v92
    v_cvt_pk_bf16_f32 v92, v3, v3
    v_and_b32 v40, v92, v152
    v_and_b32 v41, v92, v153
    v_and_b32 v42, v92, v154
    v_and_b32 v43, v92, v155
    v_bfe_u32 v3, v1, 3, 1
    v_mul_u32_u24 v3, 768, v3
    v_lshl_add_u32 v3, v5, 5, v3
    v_and_b32_e64 v4, 16, v1
    s_mul_i32 s28, s3, 1536
    s_add_u32 s28, s28, 98432
    v_add3_u32 v22, v3, v4, s28
    v_lshlrev_b32_e64 v23, 2, v1
    v_add_u32 v23, 98432, v23
    v_lshlrev_b32_e64 v10, 4, v1
    v_mul_u32_u24 v6, 3072, v2
    v_lshl_add_u32 v6, v5, 4, v6
    s_mul_i32 s44, s46, 122880
    s_mul_i32 s27, s24, 384
    s_add_u32 s44, s44, s27
    s_movk_i32 s45, 24576
    v_and_b32 v18, 15, v1
    v_lshrrev_b32 v19, 4, v1
    v_and_b32 v3, 15, v1
    v_lshlrev_b32 v3, 5, v3
    v_and_b32_e64 v4, 16, v1
    s_mul_i32 s27, s3, 2560
    s_add_u32 s27, s27, 112768
    v_add3_u32 v156, v3, v4, s27
    s_mul_i32 s27, s3, 640
    v_lshl_add_u32 v158, v1, 4, s27
    v_add_u32 v157, 112768, v158
    v_mul_u32_u24 v3, 1280, v19
    v_lshl_add_u32 v159, v18, 4, v3
    v_lshlrev_b32 v3, 10, v18
    v_lshl_add_u32 v160, v19, 4, v3
    s_lshr_b32 s87, s25, 2
    s_lshl_b32 s27, s24, 2
    s_add_u32 s87, s87, s27
    s_and_b32 s27, s25, 3
    s_lshl_b32 s27, s27, 2
    s_add_u32 s27, s27, s3
    s_mul_i32 s84, s87, 48
    s_add_u32 s84, s84, s27
    s_mulk_i32 s84, 5120
    s_add_u32 s85, s84, 81920
    s_add_u32 s86, s84, 163840
    s_mulk_i32 s87, 12288
    s_lshl_b32 s27, s27, 6
    s_add_u32 s87, s87, s27
    s_add_u32 s87, s87, 851968
    s_lshl_b32 s88, s24, 4
    s_add_u32 s88, s88, s25
    s_lshl_b32 s83, s3, 13
    s_add_u32 s83, s83, 1376256
    s_mulk_i32 s88, 2560
    s_add_u32 s88, s88, 2228224
    v_mov_b32 v164, 0
    v_mov_b32 v165, 0
    v_mov_b32 v166, 0
    v_mov_b32 v161, 1
    s_and_b32 s28, s25, 3
    s_xor_b32 s28, s28, 3
    s_lshr_b32 s27, s3, 0
    s_or_b32 s28, s28, s27
    v_lshlrev_b32 v3, 7, v1
    s_cmp_eq_u32 s28, 0
    s_cselect_b32 s27, 40, 0
    v_cmp_gt_u32_e64 vcc, s27, v1
    v_mov_b32 v162, 0x20000000
    s_nop 0
    v_cndmask_b32 v162, v162, v3, vcc
    v_mov_b32 v163, 0x20000000
    s_mov_b32 s10, 1966080
    s_mov_b32 s11, 0x20000
    s_mov_b32 s98, 3072
    s_mov_b32 s99, 0x20000
    s_mul_i32 s27, s24, 48
    s_add_u32 s27, s27, s46
    s_mul_i32 s38, s27, 5120
    s_add_u32 s39, s38, 81920
    s_add_u32 s40, s38, 163840
    s_lshl_b32 s47, s27, 3
    s_lshl_b32 s41, s89, 10
    s_add_u32 s41, s41, 32768
    s_mul_i32 s43, s89, 2560
    s_add_u32 s43, s43, 2555904
    s_lshl_b32 s42, s24, 12
    s_lshl_b32 s27, s46, 6
    s_add_u32 s42, s42, s27
    s_add_u32 s42, s42, 32768
    v_and_b32 v3, 3, v1
    v_lshlrev_b32_e64 v3, 10, v3
    v_lshl_add_u32 v59, v19, 4, v3
    v_and_b32 v3, 15, v1
    v_lshlrev_b32 v3, 5, v3
    v_and_b32 v4, 16, v1
    s_mul_i32 s27, s3, 2560
    s_add_u32 s27, s27, 0
    v_add3_u32 v11, v3, v4, s27
    s_mul_i32 s27, s3, 640
    v_lshl_add_u32 v13, v1, 4, s27
    v_add_u32 v12, 0, v13
    s_waitcnt vmcnt(0)
    s_barrier
    s_mov_b32 s94, 1
    s_cmp_lg_u32 s3, 0
    s_cbranch_scc1 L_F1_noadd
    s_atomic_add s94, s[30:31], 128
L_F1_noadd:
    v_min_u32 v14, 143, v0
    v_lshlrev_b32_e64 v14, 7, v14
    buffer_load_dword v15, v14, s[16:19], s36 offen sc1
    v_min_u32 v14, 95, v0
    v_lshlrev_b32_e64 v14, 7, v14
    s_mul_i32 s27, s89, 12288
    s_add_u32 s27, s27, 851968
    buffer_load_dword v15, v14, s[16:19], s27 offen sc1
    v_lshlrev_b32_e64 v3, 1, v19
    buffer_load_ushort v56, v3, s[96:99], s47 offen offset:0
    buffer_load_ushort v57, v3, s[96:99], s47 offen offset:128
    buffer_load_ushort v58, v3, s[96:99], s47 offen offset:256
    s_waitcnt vmcnt(4)
    buffer_load_dwordx4 a[64:67], v6, s[12:15], s44 offen offset:0 nt
    s_waitcnt vmcnt(4)
    buffer_load_dwordx4 a[68:71], v6, s[12:15], s44 offen offset:128 nt
    s_waitcnt vmcnt(4)
    buffer_load_dwordx4 a[72:75], v6, s[12:15], s44 offen offset:256 nt
    s_add_u32 s44, s44, s45
    s_waitcnt vmcnt(4)
    buffer_load_dwordx4 a[76:79], v6, s[12:15], s44 offen offset:0 nt
    s_waitcnt vmcnt(4)
    buffer_load_dwordx4 a[80:83], v6, s[12:15], s44 offen offset:128 nt
    s_waitcnt vmcnt(4)
    buffer_load_dwordx4 a[84:87], v6, s[12:15], s44 offen offset:256 nt
    s_add_u32 s44, s44, s45
    s_waitcnt vmcnt(4)
    buffer_load_dwordx4 a[88:91], v6, s[12:15], s44 offen offset:0 nt
    s_waitcnt vmcnt(4)
    buffer_load_dwordx4 a[92:95], v6, s[12:15], s44 offen offset:128 nt
    s_waitcnt vmcnt(4)
    buffer_load_dwordx4 a[96:99], v6, s[12:15], s44 offen offset:256 nt
    s_add_u32 s44, s44, s45
    s_waitcnt vmcnt(4)
    buffer_load_dwordx4 a[100:103], v6, s[12:15], s44 offen offset:0 nt
    s_waitcnt vmcnt(4)
    buffer_load_dwordx4 a[104:107], v6, s[12:15], s44 offen offset:128 nt
    s_load_dword s92, s[30:31], 0
    s_waitcnt vmcnt(4)
    buffer_load_dwordx4 a[108:111], v6, s[12:15], s44 offen offset:256 nt
    s_add_u32 s44, s44, s45
    s_waitcnt vmcnt(4)
    buffer_load_dwordx4 a[112:115], v6, s[12:15], s44 offen offset:0 nt
    s_waitcnt vmcnt(4)
    buffer_load_dwordx4 a[116:119], v6, s[12:15], s44 offen offset:128 nt
    s_waitcnt vmcnt(4)
    buffer_load_dwordx4 a[120:123], v6, s[12:15], s44 offen offset:256 nt
    s_waitcnt lgkmcnt(0)
    s_cmp_lt_u32 s92, 32
    s_cbranch_scc1 L_F_fslow
L_F_fok:
    s_getreg_b32 s80, hwreg(HW_REG_XCC_ID, 0, 4)
    s_lshl_b32 s80, s80, 2
    s_lshl_b32 s93, s24, 7
    s_add_u32 s80, s80, s93
    s_add_u32 s80, s80, 1310720
    s_cmp_lg_u32 s3, 0
    s_cbranch_scc1 L_F_nocensus
    s_mov_b32 s93, 1
    s_atomic_add s93, s[16:17], s80
L_F_nocensus:
    v_mfma_f32_16x16x32_bf16 v[44:47], v[24:27], a[64:67], 0
    v_mfma_f32_16x16x32_bf16 v[48:51], v[24:27], a[68:71], 0
    v_mfma_f32_16x16x32_bf16 v[52:55], v[24:27], a[72:75], 0
    v_mfma_f32_16x16x32_bf16 v[44:47], v[28:31], a[76:79], v[44:47]
    v_mfma_f32_16x16x32_bf16 v[48:51], v[28:31], a[80:83], v[48:51]
    v_mfma_f32_16x16x32_bf16 v[52:55], v[28:31], a[84:87], v[52:55]
    v_mfma_f32_16x16x32_bf16 v[44:47], v[32:35], a[88:91], v[44:47]
    v_mfma_f32_16x16x32_bf16 v[48:51], v[32:35], a[92:95], v[48:51]
    v_mfma_f32_16x16x32_bf16 v[52:55], v[32:35], a[96:99], v[52:55]
    s_waitcnt vmcnt(4)
    buffer_load_dwordx4 a[128:131], v159, s[8:11], s38 offen offset:0 nt
    s_waitcnt vmcnt(4)
    buffer_load_dwordx4 a[132:135], v159, s[8:11], s38 offen offset:256 nt
    v_mfma_f32_16x16x32_bf16 v[44:47], v[36:39], a[100:103], v[44:47]
    v_mfma_f32_16x16x32_bf16 v[48:51], v[36:39], a[104:107], v[48:51]
    v_mfma_f32_16x16x32_bf16 v[52:55], v[36:39], a[108:111], v[52:55]
    s_waitcnt vmcnt(4)
    buffer_load_dwordx4 a[136:139], v159, s[8:11], s38 offen offset:512 nt
    s_waitcnt vmcnt(4)
    buffer_load_dwordx4 a[140:143], v159, s[8:11], s38 offen offset:768 nt
    s_waitcnt vmcnt(4)
    buffer_load_dwordx4 a[144:147], v159, s[8:11], s38 offen offset:1024 nt
    v_mfma_f32_16x16x32_bf16 v[44:47], v[40:43], a[112:115], v[44:47]
    v_mfma_f32_16x16x32_bf16 v[48:51], v[40:43], a[116:119], v[48:51]
    v_mfma_f32_16x16x32_bf16 v[52:55], v[40:43], a[120:123], v[52:55]
    s_mov_b32 exec_lo, 0x00ff00ff
    s_mov_b32 exec_hi, 0xff00ff00
    s_nop 3
    ds_write_b128 v22, v[44:47] offset:0
    ds_write_b128 v22, v[48:51] offset:256
    ds_write_b128 v22, v[52:55] offset:512
    s_mov_b64 exec, -1
    s_waitcnt lgkmcnt(0)
    s_barrier
    s_cmp_lg_u32 s3, 0
    s_cbranch_scc1 L_F_h_nopub
    ds_read2st64_b32 v[64:65], v23 offset0:0 offset1:1
    ds_read2st64_b32 v[66:67], v23 offset0:2 offset1:3
    ds_read2st64_b32 v[68:69], v23 offset0:4 offset1:5
    ds_read2st64_b32 v[70:71], v23 offset0:6 offset1:7
    ds_read2st64_b32 v[72:73], v23 offset0:8 offset1:9
    ds_read2st64_b32 v[74:75], v23 offset0:10 offset1:11
    ds_read2st64_b32 v[76:77], v23 offset0:12 offset1:13
    ds_read2st64_b32 v[78:79], v23 offset0:14 offset1:15
    ds_read2st64_b32 v[80:81], v23 offset0:16 offset1:17
    ds_read2st64_b32 v[82:83], v23 offset0:18 offset1:19
    ds_read2st64_b32 v[84:85], v23 offset0:20 offset1:21
    ds_read2st64_b32 v[86:87], v23 offset0:22 offset1:23
    v_mov_b32 v143, s26
    s_waitcnt lgkmcnt(6)
    v_add_f32 v140, v64, v67
    v_add_f32 v141, v65, v68
    v_add_f32 v142, v66, v69
    v_add_f32 v140, v140, v70
    v_add_f32 v141, v141, v71
    v_add_f32 v142, v142, v72
    v_add_f32 v140, v140, v73
    v_add_f32 v141, v141, v74
    v_add_f32 v142, v142, v75
    s_waitcnt lgkmcnt(0)
    v_add_f32 v140, v140, v76
    v_add_f32 v141, v141, v77
    v_add_f32 v142, v142, v78
    v_add_f32 v140, v140, v79
    v_add_f32 v141, v141, v80
    v_add_f32 v142, v142, v81
    v_add_f32 v140, v140, v82
    v_add_f32 v141, v141, v83
    v_add_f32 v142, v142, v84
    v_add_f32 v140, v140, v85
    v_add_f32 v141, v141, v86
    v_add_f32 v142, v142, v87
    buffer_store_dwordx4 v[140:143], v10, s[16:19], s41 offen sc1
L_F_h_nopub:
    buffer_load_dwordx4 a[148:151], v159, s[8:11], s39 offen offset:0 nt
    s_waitcnt vmcnt(5)
    buffer_load_dwordx4 a[152:155], v159, s[8:11], s39 offen offset:256 nt
    s_waitcnt vmcnt(5)
    buffer_load_dwordx4 a[156:159], v159, s[8:11], s39 offen offset:512 nt
    s_waitcnt vmcnt(5)
    buffer_load_dwordx4 a[160:163], v159, s[8:11], s39 offen offset:768 nt
    s_waitcnt vmcnt(5)
    buffer_load_dwordx4 a[164:167], v159, s[8:11], s39 offen offset:1024 nt
    s_waitcnt vmcnt(5)
    buffer_load_dwordx4 a[168:171], v159, s[8:11], s40 offen offset:0 nt
    s_waitcnt vmcnt(5)
    buffer_load_dwordx4 a[172:175], v159, s[8:11], s40 offen offset:256 nt
    s_waitcnt vmcnt(5)
    buffer_load_dwordx4 a[176:179], v159, s[8:11], s40 offen offset:512 nt
    s_waitcnt vmcnt(5)
    buffer_load_dwordx4 a[180:183], v159, s[8:11], s40 offen offset:768 nt
    s_waitcnt vmcnt(5)
    buffer_load_dwordx4 a[184:187], v159, s[8:11], s40 offen offset:1024 nt
    buffer_load_dwordx4 v[60:63], v59, s[16:19], s42 offen sc1
    s_load_dword s92, s[30:31], 128
    s_waitcnt vmcnt(5)
    buffer_load_dwordx4 a[192:195], v159, s[20:23], s84 offen offset:0 nt
    s_waitcnt vmcnt(5)
    buffer_load_dwordx4 a[196:199], v159, s[20:23], s84 offen offset:256 nt
    s_waitcnt vmcnt(5)
    buffer_load_dwordx4 a[200:203], v159, s[20:23], s84 offen offset:512 nt
    s_waitcnt vmcnt(5)
    buffer_load_dwordx4 a[204:207], v159, s[20:23], s84 offen offset:768 nt
    s_waitcnt vmcnt(5)
    buffer_load_dwordx4 a[208:211], v159, s[20:23], s84 offen offset:1024 nt
    s_waitcnt vmcnt(5)
    s_waitcnt lgkmcnt(0)
    s_cmp_lt_u32 s92, 32
    s_cbranch_scc1 L_F1_fslow
L_F1_fok:
    v_cmp_ne_u32 vcc, s26, v63
    s_cbranch_vccnz L_F_xh_slow
L_F_xh_ok:
    v_add_f32 v60, v60, v60 quad_perm:[1,0,3,2] row_mask:0xf bank_mask:0xf
    v_add_f32 v61, v61, v61 quad_perm:[1,0,3,2] row_mask:0xf bank_mask:0xf
    v_add_f32 v62, v62, v62 quad_perm:[1,0,3,2] row_mask:0xf bank_mask:0xf
    v_add_f32 v60, v60, v60 quad_perm:[2,3,0,1] row_mask:0xf bank_mask:0xf
    v_add_f32 v61, v61, v61 quad_perm:[2,3,0,1] row_mask:0xf bank_mask:0xf
    v_add_f32 v62, v62, v62 quad_perm:[2,3,0,1] row_mask:0xf bank_mask:0xf
    v_cvt_pk_bf16_f32 v60, v60, v60
    v_and_b32 v60, 0xffff0000, v60
    v_lshlrev_b32 v3, 16, v56
    v_add_f32 v60, v60, v3
    v_cvt_pk_bf16_f32 v60, v60, v60
    v_and_b32 v60, 0xffff0000, v60
    v_mul_f32_e64 v3, v60, v60
    v_mul_f32 v3, 0x3d372713, v3
    v_add_f32 v3, 1.0, v3
    v_mul_f32 v3, v3, v60
    buffer_load_dwordx4 a[212:215], v159, s[20:23], s85 offen offset:0 nt
    v_mul_f32 v3, 0xc0135761, v3
    v_exp_f32 v3, v3
    s_nop 0
    v_add_f32 v3, 1.0, v3
    v_rcp_f32 v3, v3
    s_nop 0
    v_mul_f32 v60, v60, v3
    v_cvt_pk_bf16_f32 v61, v61, v61
    v_and_b32 v61, 0xffff0000, v61
    v_lshlrev_b32 v3, 16, v57
    v_add_f32 v61, v61, v3
    v_cvt_pk_bf16_f32 v61, v61, v61
    v_and_b32 v61, 0xffff0000, v61
    v_mul_f32_e64 v3, v61, v61
    v_mul_f32 v3, 0x3d372713, v3
    v_add_f32 v3, 1.0, v3
    v_mul_f32 v3, v3, v61
    v_mul_f32 v3, 0xc0135761, v3
    buffer_load_dwordx4 a[216:219], v159, s[20:23], s85 offen offset:256 nt
    v_exp_f32 v3, v3
    s_nop 0
    v_add_f32 v3, 1.0, v3
    v_rcp_f32 v3, v3
    s_nop 0
    v_mul_f32 v61, v61, v3
    v_cvt_pk_bf16_f32 v62, v62, v62
    v_and_b32 v62, 0xffff0000, v62
    v_lshlrev_b32 v3, 16, v58
    v_add_f32 v62, v62, v3
    v_cvt_pk_bf16_f32 v62, v62, v62
    v_and_b32 v62, 0xffff0000, v62
    v_mul_f32_e64 v3, v62, v62
    v_mul_f32 v3, 0x3d372713, v3
    v_add_f32 v3, 1.0, v3
    v_mul_f32 v3, v3, v62
    v_mul_f32 v3, 0xc0135761, v3
    v_exp_f32_e64 v3, v3
    buffer_load_dwordx4 a[220:223], v159, s[20:23], s85 offen offset:512 nt
    v_add_f32 v3, 1.0, v3
    v_rcp_f32 v3, v3
    s_nop 0
    v_mul_f32 v62, v62, v3
    v_cvt_pk_bf16_f32 v60, v60, v60
    v_cvt_pk_bf16_f32 v61, v61, v61
    v_cvt_pk_bf16_f32 v62, v62, v62
    v_and_b32 v72, v60, v152
    v_and_b32 v73, v60, v153
    v_and_b32 v74, v60, v154
    v_and_b32 v75, v60, v155
    buffer_load_dwordx4 a[224:227], v159, s[20:23], s85 offen offset:768 nt
    s_nop 0
    v_mfma_f32_16x16x32_bf16 v[88:91], v[72:75], a[128:131], 0
    v_and_b32 v76, v61, v152
    v_and_b32_e64 v77, v61, v153
    v_mfma_f32_16x16x32_bf16 v[92:95], v[72:75], a[132:135], 0
    v_and_b32 v78, v61, v154
    v_and_b32 v79, v61, v155
    v_mfma_f32_16x16x32_bf16 v[96:99], v[72:75], a[136:139], 0
    v_and_b32 v80, v62, v152
    v_and_b32 v81, v62, v153
    v_mfma_f32_16x16x32_bf16 v[88:91], v[76:79], a[148:151], v[88:91]
    v_and_b32 v82, v62, v154
    v_and_b32 v83, v62, v155
    v_mfma_f32_16x16x32_bf16 v[92:95], v[76:79], a[152:155], v[92:95]
    buffer_load_dwordx4 a[228:231], v159, s[20:23], s85 offen offset:1024 nt
    v_mfma_f32_16x16x32_bf16 v[88:91], v[80:83], a[168:171], v[88:91]
    s_nop 1
    v_mfma_f32_16x16x32_bf16 v[92:95], v[80:83], a[172:175], v[92:95]
    s_nop 1
    v_mfma_f32_16x16x32_bf16 v[96:99], v[76:79], a[156:159], v[96:99]
    s_nop 1
    v_mfma_f32_16x16x32_bf16 v[96:99], v[80:83], a[176:179], v[96:99]
    ds_write_b128 v11, v[88:91] offset:0
    s_nop 0
    v_mfma_f32_16x16x32_bf16 v[100:103], v[72:75], a[140:143], 0
    ds_write_b128 v11, v[92:95] offset:512
    s_nop 0
    buffer_load_dwordx4 a[232:235], v159, s[20:23], s86 offen offset:0 nt
    v_mfma_f32_16x16x32_bf16 v[100:103], v[76:79], a[160:163], v[100:103]
    s_nop 1
    v_mfma_f32_16x16x32_bf16 v[100:103], v[80:83], a[180:183], v[100:103]
    ds_write_b128 v11, v[96:99] offset:1024
    s_nop 0
    v_mfma_f32_16x16x32_bf16 v[104:107], v[72:75], a[144:147], 0
    s_nop 1
    v_mfma_f32_16x16x32_bf16 v[104:107], v[76:79], a[164:167], v[104:107]
    s_nop 1
    v_mfma_f32_16x16x32_bf16 v[104:107], v[80:83], a[184:187], v[104:107]
    ds_write_b128 v11, v[100:103] offset:1536
    buffer_load_dwordx4 a[236:239], v159, s[20:23], s86 offen offset:256 nt
    s_nop 5
    ds_write_b128 v11, v[104:107] offset:2048
    s_mov_b32 exec_hi, 0xff
    s_waitcnt lgkmcnt(0)
    s_barrier
    ds_read_b128 v[72:75], v12 offset:0
    ds_read_b128 v[76:79], v12 offset:2560
    ds_read_b128 v[80:83], v12 offset:5120
    ds_read_b128 v[84:87], v12 offset:7680
    s_waitcnt lgkmcnt(2)
    v_pk_add_f32 v[72:73], v[72:73], v[76:77]
    v_pk_add_f32 v[74:75], v[74:75], v[78:79]
    s_waitcnt lgkmcnt(0)
    v_pk_add_f32 v[80:81], v[80:81], v[84:85]
    v_pk_add_f32 v[82:83], v[82:83], v[86:87]
    v_pk_add_f32 v[74:75], v[74:75], v[82:83]
    v_pk_add_f32 v[72:73], v[72:73], v[80:81]
    v_min_u32_e64 v75, -2, v75
    buffer_store_dwordx4 v[72:75], v13, s[16:19], s43 offen sc1
    s_mov_b64 exec, -1
    s_waitcnt vmcnt(5)
    buffer_load_dwordx4 a[240:243], v159, s[20:23], s86 offen offset:512 nt
    s_waitcnt vmcnt(5)
    buffer_load_dwordx4 a[244:247], v159, s[20:23], s86 offen offset:768 nt
    s_waitcnt vmcnt(5)
    buffer_load_dwordx4 a[248:251], v159, s[20:23], s86 offen offset:1024 nt
    s_mov_b32 s80, 31
    s_branch L_T
L_H_fslow:
    s_mov_b32 s92, 0
    v_and_b32 v252, 1, v1
    v_mul_u32_u24 v252, 0, v252
L_H_floop:
    s_sleep 24
    global_load_dword v253, v252, s[30:31] offset:0 sc1
    s_add_u32 s92, s92, 1
    s_waitcnt vmcnt(0)
    v_cmp_gt_u32_e64 vcc, 32, v253
    s_cbranch_vccz L_H_fok
    s_cmp_lt_u32 s92, 200000
    s_cbranch_scc1 L_H_floop
    s_branch L_H_fok
L_H_xq_slow:
    s_mov_b32 s28, 0
L_H_xq_loop:
    buffer_load_dwordx4 v[16:19], v10, s[16:19], s41 offen offset:0 sc1
    buffer_load_dwordx4 v[20:23], v10, s[16:19], s41 offen offset:1024 sc1
    buffer_load_dwordx4 v[24:27], v10, s[16:19], s41 offen offset:2048 sc1
    buffer_load_dwordx4 v[28:31], v10, s[16:19], s41 offen offset:3072 sc1
    s_add_u32 s28, s28, 1
    s_waitcnt vmcnt(0)
    v_min3_u32 v4, s26, v19, v23
    v_max3_u32 v5, s26, v19, v23
    v_min3_u32 v4, v4, v27, v31
    v_max3_u32 v5, v5, v27, v31
    v_cmp_ne_u32 vcc, v4, v5
    s_cbranch_vccz L_H_xq_ok
    s_cmp_lt_u32 s28, 200000
    s_cbranch_scc1 L_H_xq_loop
    s_branch L_H_xq_ok
L_H1_fslow:
    s_mov_b32 s92, 0
    v_and_b32 v252, 1, v1
    v_mul_u32_u24 v252, 0, v252
L_H1_floop:
    s_sleep 24
    global_load_dword v253, v252, s[30:31] offset:128 sc1
    s_add_u32 s92, s92, 1
    s_waitcnt vmcnt(0)
    v_cmp_gt_u32_e64 vcc, 32, v253
    s_cbranch_vccz L_H1_fok
    s_cmp_lt_u32 s92, 200000
    s_cbranch_scc1 L_H1_floop
    s_branch L_H1_fok
L_H_x3_retry:
    s_cmp_ge_u32 s28, 200000
    s_cbranch_scc1 L_H_x3_ok
    s_mov_b32 m0, s41
    s_add_u32 s28, s28, 1
    buffer_load_dwordx4 v24, s[16:19], s40 offen sc1 lds
    s_add_u32 m0, m0, 1024
    s_nop 0
    buffer_load_dwordx4 v25, s[16:19], s40 offen sc1 lds
    buffer_load_dwordx2 v[40:41], v36, s[16:19], s42 offen sc1
    s_waitcnt vmcnt(0)
    s_branch L_H_x3
L_T_x4_long:
    s_cmp_lg_u32 s28, 24
    s_cbranch_scc1 L_T_x4_nore
    s_mov_b64 exec, -1
    buffer_store_dwordx4 v[28:31], v163, s[16:19], s43 offen sc1
    s_mov_b32 exec_lo, 0x0fff0fff
    s_mov_b32 exec_hi, 0x0fff0fff
L_T_x4_nore:
    s_cmp_lt_u32 s28, 200000
    s_cbranch_scc1 L_T_x4_chk
    s_waitcnt vmcnt(0)
    s_branch L_T_x4_ok
L_A_fslow:
    s_mov_b32 s92, 0
    v_and_b32_e64 v252, 1, v1
    v_mul_u32_u24 v252, 0, v252
L_A_floop:
    s_sleep 24
    global_load_dword v253, v252, s[30:31] offset:128 sc1
    s_add_u32 s92, s92, 1
    s_waitcnt vmcnt(0)
    v_cmp_gt_u32 vcc, 32, v253
    s_cbranch_vccz L_A_fok
    s_cmp_lt_u32 s92, 200000
    s_cbranch_scc1 L_A_floop
    s_branch L_A_fok
L_A_n2_late:
    buffer_store_dwordx4 v[232:235], v10, s[16:19], s88 offen sc1
    s_branch L_A_n2_go
L_A_x2_slow:
    s_mov_b32 s28, 0
L_A_x2_loop:
    buffer_load_dwordx4 v[64:67], v224, s[16:19], s38 offen sc1
    buffer_load_dwordx4 v[68:71], v225, s[16:19], s38 offen sc1
    buffer_load_dwordx4 v[72:75], v226, s[16:19], s38 offen sc1
    buffer_load_dwordx4 v[76:79], v227, s[16:19], s38 offen sc1
    buffer_load_dwordx4 v[80:83], v224, s[16:19], s39 offen sc1
    buffer_load_dwordx4 v[84:87], v225, s[16:19], s39 offen sc1
    buffer_load_dwordx4 v[88:91], v226, s[16:19], s39 offen sc1
    buffer_load_dwordx4 v[92:95], v227, s[16:19], s39 offen sc1
    buffer_load_dwordx4 v[96:99], v224, s[16:19], s40 offen sc1
    buffer_load_dwordx4 v[100:103], v225, s[16:19], s40 offen sc1
    buffer_load_dwordx4 v[104:107], v226, s[16:19], s40 offen sc1
    buffer_load_dwordx4 v[108:111], v227, s[16:19], s40 offen sc1
    v_mov_b32_e64 v11, 0
    s_add_u32 s28, s28, 1
    s_waitcnt vmcnt(0)
    v_max3_u32 v11, v11, v67, v71
    v_max3_u32 v11, v11, v75, v79
    v_max3_u32 v11, v11, v83, v87
    v_max3_u32 v11, v11, v91, v95
    v_max3_u32 v11, v11, v99, v103
    v_max3_u32 v11, v11, v107, v111
    v_cmp_eq_u32_e64 vcc, -1, v11
    s_cbranch_vccz L_A_x2_redo
    s_cmp_lt_u32 s28, 200000
    s_cbranch_scc1 L_A_x2_loop
L_A_x2_redo:
    v_mfma_f32_32x32x16_bf16 v[112:127], a[160:163], v[64:67], 0
    v_mfma_f32_32x32x16_bf16 v[128:143], a[208:211], v[64:67], 0
    v_mfma_f32_32x32x16_bf16 v[112:127], a[164:167], v[68:71], v[112:127]
    v_mfma_f32_32x32x16_bf16 v[128:143], a[212:215], v[68:71], v[128:143]
    v_mfma_f32_32x32x16_bf16 v[112:127], a[168:171], v[72:75], v[112:127]
    v_mfma_f32_32x32x16_bf16 v[128:143], a[216:219], v[72:75], v[128:143]
    v_mfma_f32_32x32x16_bf16 v[112:127], a[172:175], v[76:79], v[112:127]
    v_mfma_f32_32x32x16_bf16 v[128:143], a[220:223], v[76:79], v[128:143]
    v_mfma_f32_32x32x16_bf16 v[112:127], a[176:179], v[80:83], v[112:127]
    v_mfma_f32_32x32x16_bf16 v[128:143], a[224:227], v[80:83], v[128:143]
    v_mfma_f32_32x32x16_bf16 v[112:127], a[180:183], v[84:87], v[112:127]
    v_mfma_f32_32x32x16_bf16 v[128:143], a[228:231], v[84:87], v[128:143]
    v_mfma_f32_32x32x16_bf16 v[112:127], a[184:187], v[88:91], v[112:127]
    v_mfma_f32_32x32x16_bf16 v[128:143], a[232:235], v[88:91], v[128:143]
    v_mfma_f32_32x32x16_bf16 v[112:127], a[188:191], v[92:95], v[112:127]
    v_mfma_f32_32x32x16_bf16 v[128:143], a[236:239], v[92:95], v[128:143]
    v_mfma_f32_32x32x16_bf16 v[112:127], a[192:195], v[96:99], v[112:127]
    v_mfma_f32_32x32x16_bf16 v[128:143], a[240:243], v[96:99], v[128:143]
    v_mfma_f32_32x32x16_bf16 v[112:127], a[196:199], v[100:103], v[112:127]
    v_mfma_f32_32x32x16_bf16 v[128:143], a[244:247], v[100:103], v[128:143]
    v_mfma_f32_32x32x16_bf16 v[112:127], a[200:203], v[104:107], v[112:127]
    v_mfma_f32_32x32x16_bf16 v[128:143], a[248:251], v[104:107], v[128:143]
    v_mfma_f32_32x32x16_bf16 v[112:127], a[204:207], v[108:111], v[112:127]
    v_mfma_f32_32x32x16_bf16 v[128:143], a[252:255], v[108:111], v[128:143]
    s_branch L_A_x2_ok
L_A_m_long:
    s_cmp_lg_u32 s28, 24
    s_cbranch_scc1 L_A_m_nore
    buffer_store_dwordx4 v[12:15], v10, s[16:19], s42 offen sc1
    buffer_store_dword v4, v32, s[16:19], s43 offen sc1
L_A_m_nore:
    s_cmp_lt_u32 s28, 200000
    s_cbranch_scc1 L_A_m_chk
    s_waitcnt vmcnt(0)
    s_branch L_A_m_ok
L_A_p_slow:
    buffer_store_dwordx4 v[12:15], v10, s[16:19], s42 offen sc1
    buffer_store_dword v4, v32, s[16:19], s43 offen sc1
    s_mov_b32 s28, 0
L_A_p_loop:
    buffer_load_dwordx4 v[44:47], v34, s[16:19], s20 offen offset:0 sc1
    buffer_load_dwordx4 v[48:51], v34, s[16:19], s20 offen offset:512 sc1
    buffer_load_dwordx4 v[64:67], v33, s[16:19], s44 offen offset:0 sc1
    buffer_load_dwordx4 v[68:71], v33, s[16:19], s44 offen offset:512 sc1
    buffer_load_dwordx4 v[72:75], v33, s[16:19], s44 offen offset:1024 sc1
    buffer_load_dwordx4 v[76:79], v33, s[16:19], s44 offen offset:1536 sc1
    buffer_load_dwordx4 v[80:83], v33, s[16:19], s44 offen offset:2048 sc1
    buffer_load_dwordx4 v[84:87], v33, s[16:19], s44 offen offset:2560 sc1
    buffer_load_dwordx4 v[88:91], v33, s[16:19], s44 offen offset:3072 sc1
    buffer_load_dwordx4 v[92:95], v33, s[16:19], s44 offen offset:3584 sc1
    buffer_load_dwordx4 v[96:99], v33, s[16:19], s45 offen offset:0 sc1
    buffer_load_dwordx4 v[100:103], v33, s[16:19], s45 offen offset:512 sc1
    buffer_load_dwordx4 v[104:107], v33, s[16:19], s45 offen offset:1024 sc1
    buffer_load_dwordx4 v[108:111], v33, s[16:19], s45 offen offset:1536 sc1
    buffer_load_dwordx4 v[112:115], v33, s[16:19], s45 offen offset:2048 sc1
    buffer_load_dwordx4 v[116:119], v33, s[16:19], s45 offen offset:2560 sc1
    buffer_load_dwordx4 v[120:123], v33, s[16:19], s45 offen offset:3072 sc1
    buffer_load_dwordx4 v[124:127], v33, s[16:19], s45 offen offset:3584 sc1
    s_add_u32 s28, s28, 1
    s_waitcnt vmcnt(0)
    v_max3_u32 v11, v44, v45, v46
    v_max3_u32 v11, v11, v47, v48
    v_max3_u32 v11, v11, v49, v50
    v_max_u32 v11, v11, v51
    v_max3_u32 v11, v11, v67, v71
    v_max3_u32 v11, v11, v75, v79
    v_max3_u32 v11, v11, v83, v87
    v_max3_u32 v11, v11, v91, v95
    v_max3_u32 v11, v11, v99, v103
    v_max3_u32 v11, v11, v107, v111
    v_max3_u32 v11, v11, v115, v119
    v_max3_u32 v11, v11, v123, v127
    v_cmp_eq_u32_e64 vcc, -1, v11
    s_cbranch_vccz L_A_p_redo
    s_cmp_lt_u32 s28, 200000
    s_cbranch_scc1 L_A_p_loop
L_A_p_redo:
    v_max3_f32 v60, v44, v45, v46
    v_max3_f32 v61, v47, v48, v49
    v_max3_f32 v60, v60, v50, v51
    v_max_f32 v60, v60, v61
    v_mov_b32 v61, v60
    s_nop 1
    v_permlane32_swap_b32 v60, v61
    v_max_f32 v60, v60, v61
    v_mov_b32 v61, v60
    s_nop 1
    v_permlane16_swap_b32 v60, v61
    v_max_f32 v60, v60, v61
    v_sub_f32 v52, v60, v44
    v_cvt_pk_u8_f32 v52, v52, 0, 0
    v_mul_u32_u24 v52, 0x800080, v52
    v_pk_sub_u16 v67, v67, v52 clamp
    v_pk_sub_u16 v64, v64, v52 clamp
    v_pk_sub_u16 v65, v65, v52 clamp
    v_pk_sub_u16 v66, v66, v52 clamp
    s_nop 1
    v_mfma_f32_16x16x32_bf16 v[136:139], a[0:3], v[64:67], 0
    v_mfma_f32_16x16x32_bf16 v[140:143], a[4:7], v[64:67], 0
    v_mfma_f32_16x16x32_bf16 v[144:147], a[8:11], v[64:67], 0
    v_pk_sub_u16 v71, v71, v52 clamp
    v_pk_sub_u16 v68, v68, v52 clamp
    v_pk_sub_u16 v69, v69, v52 clamp
    v_pk_sub_u16 v70, v70, v52 clamp
    s_nop 1
    v_mfma_f32_16x16x32_bf16 v[136:139], a[12:15], v[68:71], v[136:139]
    v_mfma_f32_16x16x32_bf16 v[140:143], a[16:19], v[68:71], v[140:143]
    v_mfma_f32_16x16x32_bf16 v[144:147], a[20:23], v[68:71], v[144:147]
    v_sub_f32_e64 v53, v60, v45
    v_cvt_pk_u8_f32 v53, v53, 0, 0
    v_mul_u32_u24 v53, 0x800080, v53
    v_pk_sub_u16 v75, v75, v53 clamp
    v_pk_sub_u16 v72, v72, v53 clamp
    v_pk_sub_u16 v73, v73, v53 clamp
    v_pk_sub_u16 v74, v74, v53 clamp
    s_nop 1
    v_mfma_f32_16x16x32_bf16 v[136:139], a[24:27], v[72:75], v[136:139]
    v_mfma_f32_16x16x32_bf16 v[140:143], a[28:31], v[72:75], v[140:143]
    v_mfma_f32_16x16x32_bf16 v[144:147], a[32:35], v[72:75], v[144:147]
    v_pk_sub_u16 v79, v79, v53 clamp
    v_pk_sub_u16 v76, v76, v53 clamp
    v_pk_sub_u16 v77, v77, v53 clamp
    v_pk_sub_u16 v78, v78, v53 clamp
    s_nop 1
    v_mfma_f32_16x16x32_bf16 v[136:139], a[36:39], v[76:79], v[136:139]
    v_mfma_f32_16x16x32_bf16 v[140:143], a[40:43], v[76:79], v[140:143]
    v_mfma_f32_16x16x32_bf16 v[144:147], a[44:47], v[76:79], v[144:147]
    v_sub_f32_e64 v54, v60, v46
    v_cvt_pk_u8_f32 v54, v54, 0, 0
    v_mul_u32_u24 v54, 0x800080, v54
    v_pk_sub_u16 v83, v83, v54 clamp
    v_pk_sub_u16 v80, v80, v54 clamp
    v_pk_sub_u16 v81, v81, v54 clamp
    v_pk_sub_u16 v82, v82, v54 clamp
    s_nop 1
    v_mfma_f32_16x16x32_bf16 v[136:139], a[48:51], v[80:83], v[136:139]
    v_mfma_f32_16x16x32_bf16 v[140:143], a[52:55], v[80:83], v[140:143]
    v_mfma_f32_16x16x32_bf16 v[144:147], a[56:59], v[80:83], v[144:147]
    v_pk_sub_u16 v87, v87, v54 clamp
    v_pk_sub_u16 v84, v84, v54 clamp
    v_pk_sub_u16 v85, v85, v54 clamp
    v_pk_sub_u16 v86, v86, v54 clamp
    s_nop 1
    v_mfma_f32_16x16x32_bf16 v[136:139], a[60:63], v[84:87], v[136:139]
    v_mfma_f32_16x16x32_bf16 v[140:143], a[64:67], v[84:87], v[140:143]
    v_mfma_f32_16x16x32_bf16 v[144:147], a[68:71], v[84:87], v[144:147]
    v_sub_f32_e64 v55, v60, v47
    v_cvt_pk_u8_f32 v55, v55, 0, 0
    v_mul_u32_u24 v55, 0x800080, v55
    v_pk_sub_u16 v91, v91, v55 clamp
    v_pk_sub_u16 v88, v88, v55 clamp
    v_pk_sub_u16 v89, v89, v55 clamp
    v_pk_sub_u16 v90, v90, v55 clamp
    s_nop 1
    v_mfma_f32_16x16x32_bf16 v[136:139], a[72:75], v[88:91], v[136:139]
    v_mfma_f32_16x16x32_bf16 v[140:143], a[76:79], v[88:91], v[140:143]
    v_mfma_f32_16x16x32_bf16 v[144:147], a[80:83], v[88:91], v[144:147]
    v_pk_sub_u16 v95, v95, v55 clamp
    v_pk_sub_u16 v92, v92, v55 clamp
    v_pk_sub_u16 v93, v93, v55 clamp
    v_pk_sub_u16 v94, v94, v55 clamp
    s_nop 1
    v_mfma_f32_16x16x32_bf16 v[136:139], a[84:87], v[92:95], v[136:139]
    v_mfma_f32_16x16x32_bf16 v[140:143], a[88:91], v[92:95], v[140:143]
    v_mfma_f32_16x16x32_bf16 v[144:147], a[92:95], v[92:95], v[144:147]
    v_sub_f32_e64 v56, v60, v48
    v_cvt_pk_u8_f32 v56, v56, 0, 0
    v_mul_u32_u24 v56, 0x800080, v56
    v_pk_sub_u16 v99, v99, v56 clamp
    v_pk_sub_u16 v96, v96, v56 clamp
    v_pk_sub_u16 v97, v97, v56 clamp
    v_pk_sub_u16 v98, v98, v56 clamp
    s_nop 1
    v_mfma_f32_16x16x32_bf16 v[136:139], a[96:99], v[96:99], v[136:139]
    v_mfma_f32_16x16x32_bf16 v[140:143], a[100:103], v[96:99], v[140:143]
    v_mfma_f32_16x16x32_bf16 v[144:147], a[104:107], v[96:99], v[144:147]
    v_pk_sub_u16 v103, v103, v56 clamp
    v_pk_sub_u16 v100, v100, v56 clamp
    v_pk_sub_u16 v101, v101, v56 clamp
    v_pk_sub_u16 v102, v102, v56 clamp
    s_nop 1
    v_mfma_f32_16x16x32_bf16 v[136:139], a[108:111], v[100:103], v[136:139]
    v_mfma_f32_16x16x32_bf16 v[140:143], a[112:115], v[100:103], v[140:143]
    v_mfma_f32_16x16x32_bf16 v[144:147], a[116:119], v[100:103], v[144:147]
    v_sub_f32_e64 v57, v60, v49
    v_cvt_pk_u8_f32 v57, v57, 0, 0
    v_mul_u32_u24 v57, 0x800080, v57
    v_pk_sub_u16 v107, v107, v57 clamp
    v_pk_sub_u16 v104, v104, v57 clamp
    v_pk_sub_u16 v105, v105, v57 clamp
    v_pk_sub_u16 v106, v106, v57 clamp
    s_nop 1
    v_mfma_f32_16x16x32_bf16 v[136:139], a[120:123], v[104:107], v[136:139]
    v_mfma_f32_16x16x32_bf16 v[140:143], a[124:127], v[104:107], v[140:143]
    v_mfma_f32_16x16x32_bf16 v[144:147], a[128:131], v[104:107], v[144:147]
    v_pk_sub_u16 v111, v111, v57 clamp
    v_pk_sub_u16 v108, v108, v57 clamp
    v_pk_sub_u16 v109, v109, v57 clamp
    v_pk_sub_u16 v110, v110, v57 clamp
    s_nop 1
    v_mfma_f32_16x16x32_bf16 v[136:139], a[132:135], v[108:111], v[136:139]
    v_mfma_f32_16x16x32_bf16 v[140:143], a[136:139], v[108:111], v[140:143]
    v_mfma_f32_16x16x32_bf16 v[144:147], a[140:143], v[108:111], v[144:147]
    v_sub_f32_e64 v58, v60, v50
    v_cvt_pk_u8_f32 v58, v58, 0, 0
    v_mul_u32_u24 v58, 0x800080, v58
    v_pk_sub_u16 v115, v115, v58 clamp
    v_pk_sub_u16 v112, v112, v58 clamp
    v_pk_sub_u16 v113, v113, v58 clamp
    v_pk_sub_u16 v114, v114, v58 clamp
    s_nop 1
    v_mfma_f32_16x16x32_bf16 v[136:139], a[144:147], v[112:115], v[136:139]
    v_mfma_f32_16x16x32_bf16 v[140:143], a[148:151], v[112:115], v[140:143]
    v_mfma_f32_16x16x32_bf16 v[144:147], a[152:155], v[112:115], v[144:147]
    v_pk_sub_u16 v119, v119, v58 clamp
    v_pk_sub_u16 v116, v116, v58 clamp
    v_pk_sub_u16 v117, v117, v58 clamp
    v_pk_sub_u16 v118, v118, v58 clamp
    s_nop 1
    v_mfma_f32_16x16x32_bf16 v[136:139], a[156:159], v[116:119], v[136:139]
    v_mfma_f32_16x16x32_bf16 v[140:143], a[160:163], v[116:119], v[140:143]
    v_mfma_f32_16x16x32_bf16 v[144:147], a[164:167], v[116:119], v[144:147]
    v_sub_f32 v59, v60, v51
    v_cvt_pk_u8_f32 v59, v59, 0, 0
    v_mul_u32_u24 v59, 0x800080, v59
    v_pk_sub_u16 v123, v123, v59 clamp
    v_pk_sub_u16 v120, v120, v59 clamp
    v_pk_sub_u16 v121, v121, v59 clamp
    v_pk_sub_u16 v122, v122, v59 clamp
    s_nop 1
    v_mfma_f32_16x16x32_bf16 v[136:139], a[168:171], v[120:123], v[136:139]
    v_mfma_f32_16x16x32_bf16 v[140:143], a[172:175], v[120:123], v[140:143]
    v_mfma_f32_16x16x32_bf16 v[144:147], a[176:179], v[120:123], v[144:147]
    v_pk_sub_u16 v127, v127, v59 clamp
    v_pk_sub_u16 v124, v124, v59 clamp
    v_pk_sub_u16 v125, v125, v59 clamp
    v_pk_sub_u16 v126, v126, v59 clamp
    s_nop 1
    v_mfma_f32_16x16x32_bf16 v[136:139], a[180:183], v[124:127], v[136:139]
    v_mfma_f32_16x16x32_bf16 v[140:143], a[184:187], v[124:127], v[140:143]
    v_mfma_f32_16x16x32_bf16 v[144:147], a[188:191], v[124:127], v[144:147]
    s_branch L_A_p_ok
L_Z_y_r:
    s_cmp_lt_u32 s28, 200000
    s_cbranch_scc1 L_Z_y
    s_branch L_Z_y_ok
L_Z_s_r:
    s_cmp_lt_u32 s28, 200000
    s_cbranch_scc1 L_Z_s
    s_branch L_Z_s_ok
L_F_fslow:
    s_mov_b32 s92, 0
    v_and_b32 v252, 1, v1
    v_mul_u32_u24 v252, 0, v252
L_F_floop:
    s_sleep 24
    global_load_dword v253, v252, s[30:31] offset:0 sc1
    s_add_u32 s92, s92, 1
    s_waitcnt vmcnt(0)
    v_cmp_gt_u32 vcc, 32, v253
    s_cbranch_vccz L_F_fok
    s_cmp_lt_u32 s92, 200000
    s_cbranch_scc1 L_F_floop
    s_branch L_F_fok
L_F1_fslow:
    s_mov_b32 s92, 0
    v_and_b32 v252, 1, v1
    v_mul_u32_u24 v252, 0, v252
L_F1_floop:
    s_sleep 24
    global_load_dword v253, v252, s[30:31] offset:128 sc1
    s_add_u32 s92, s92, 1
    s_waitcnt vmcnt(0)
    v_cmp_gt_u32_e64 vcc, 32, v253
    s_cbranch_vccz L_F1_fok
    s_cmp_lt_u32 s92, 200000
    s_cbranch_scc1 L_F1_floop
    s_branch L_F1_fok
L_F_xh_slow:
    s_mov_b32 s28, 0
L_F_xh_loop:
    buffer_load_dwordx4 v[60:63], v59, s[16:19], s42 offen sc1
    s_add_u32 s28, s28, 1
    s_waitcnt vmcnt(0)
    v_cmp_ne_u32 vcc, s26, v63
    s_cbranch_vccz L_F_xh_ok
    s_cmp_lt_u32 s28, 200000
    s_cbranch_scc1 L_F_xh_loop
    s_branch L_F_xh_ok
L_codeend:
s_endpgm
.section .rodata,"a"
.p2align 6
.amdhsa_kernel recurrent_scan__compressed_kv_cla__dense_activation_gelu__decode_kernel
  .amdhsa_next_free_vgpr 512
  .amdhsa_next_free_sgpr 102
  .amdhsa_accum_offset 256
  .amdhsa_group_segment_fixed_size 0
  .amdhsa_kernarg_size 112
  .amdhsa_user_sgpr_count 2
  .amdhsa_user_sgpr_kernarg_segment_ptr 1
  .amdhsa_system_sgpr_workgroup_id_x 1
  .amdhsa_float_denorm_mode_32 3
.end_amdhsa_kernel
```
